```python
import torch

def _softmax(x, axis=-1):
    return torch.softmax(x, dim=axis)
def _gelu(x):
    return torch.nn.functional.gelu(x, approximate="tanh")
def _silu(x):
    return torch.nn.functional.silu(x)
def _sigmoid(x):
    return torch.sigmoid(x)
def _layernorm(x, axis=-1, eps=1e-5):
    m = x.mean(dim=axis, keepdim=True)
    v = x.var(dim=axis, keepdim=True, unbiased=False)
    return (x - m) / torch.sqrt(v + eps)
def _scatter_add(tgt, idx, src, axis=0):
    return tgt.clone().index_add_(axis, idx, src)
def _segment_sum(src, seg, n):
    out = torch.zeros((n,) + src.shape[1:], dtype=src.dtype)
    return out.index_add_(0, seg, src)
def _pad(x, pw):
    flat = tuple(v for pair in reversed(pw) for v in pair)
    return torch.nn.functional.pad(x, flat)

kernel_name = 'standalone__gqa_block_cached__near_ridge'

def setup_inputs():

    _w = (lambda a: (lambda t: t.to(torch.bfloat16) if t.is_floating_point() else t)(torch.as_tensor(a)))
    B, Sq, D = 16, 80, 576
    Hq, Hkv, Sk, Dh = 32, 16, 1024, 128
    assert Hq % Hkv == 0, (Hq, Hkv)
    return {
        "x": _w((lambda *s: torch.randn(*s, dtype=torch.bfloat16) * 0.8)(B, Sq, D)),
        "k_cache": _w((lambda *s: torch.randn(*s, dtype=torch.bfloat16) * 0.8)(B, Hkv, Sk, Dh)),
        "v_cache": _w((lambda *s: torch.randn(*s, dtype=torch.bfloat16) * 0.05)(B, Hkv, Sk, Dh)),
        "wq": _w((lambda *s: torch.randn(*s, dtype=torch.bfloat16) * 0.8)(D, Hq * Dh) * (D ** -0.5)),
        "wo": _w((lambda *s: torch.randn(*s, dtype=torch.bfloat16) * 0.05)(Hq * Dh, D) * ((Hq * Dh) ** -0.5)),
    }

def reference(x, k_cache, v_cache, wq, wo):
    B, Sq, D = x.shape
    Hq, Dh = 32, 128
    Hkv = k_cache.shape[1]
    rep = Hq // Hkv
    q = (lambda x, *d: x.permute(*d))((x @ wq).reshape(B, Sq, Hq, Dh), 0, 2, 1, 3)
    k = (lambda x, n, axis: torch.repeat_interleave(x, n, dim=axis))(k_cache, rep, axis=1)
    v = (lambda x, n, axis: torch.repeat_interleave(x, n, dim=axis))(v_cache, rep, axis=1)
    scores = torch.einsum("bhqd,bhkd->bhqk", q, k) * (Dh ** -0.5)
    p = _softmax(scores, axis=-1)
    o = torch.einsum("bhqk,bhkd->bhqd", p, v)
    return (lambda x, *d: x.permute(*d))(o, 0, 2, 1, 3).reshape(B, Sq, Hq * Dh) @ wo
```

```asm
; @launch grid=(256,1,1) block=(512,1,1) lds=163840
.amdgcn_target "amdgcn-amd-amdhsa--gfx950"
.text
.globl standalone__gqa_block_cached__near_ridge_kernel
.p2align 8
.type standalone__gqa_block_cached__near_ridge_kernel,@function
standalone__gqa_block_cached__near_ridge_kernel:
    s_cmp_ge_u32 s2, 256
    s_cbranch_scc1 L_end
    s_load_dwordx2 s[20:21], s[0:1], 24
    s_load_dwordx2 s[8:9], s[0:1], 0
    v_lshrrev_b32 v1, 6, v0
    s_and_b32 s6, s2, 7
    v_readfirstlane_b32 s38, v1
    s_bfe_u32 s39, s2, 0x10003
    s_lshl1_add_u32 s36, s6, s39
    s_lshr_b32 s37, s2, 4
    s_mov_b32 s22, 4718592
    s_mov_b32 s23, 0x20000
    s_lshl_b32 s55, s36, 9
    s_mul_i32 s41, s37, 294912
    v_lshrrev_b32 v1, 2, v0
    v_and_b32 v3, 3, v0
    v_lshlrev_b32 v1, 13, v1
    s_add_u32 s41, s41, s55
    v_lshl_add_u32 v1, v3, 7, v1
    s_cmp_ge_u32 s38, 3
    s_cbranch_scc1 L_nopf
    s_waitcnt lgkmcnt(0)
    buffer_load_dword v255, v1, s[20:23], s41 offen
L_nopf:
    v_lshlrev_b32 v4, 7, v0
    v_and_b32 v0, 63, v0
    s_and_b32 s48, s38, 1
    s_and_b32 s49, s38, 3
    v_lshrrev_b32 v223, 5, v0
    v_bfe_u32 v224, v0, 1, 4
    v_xor_b32 v224, v224, v223
    s_lshl_b32 s39, s48, 2
    v_xor_b32 v224, s39, v224
    v_lshlrev_b32 v224, 5, v224
    v_and_b32 v225, 1, v0
    v_lshl_add_u32 v224, v225, 4, v224
    v_lshl_add_u32 v240, v223, 13, v224
    v_xor_b32 v241, 64, v240
    v_add_u32 v242, 30720, v240
    v_add_u32 v243, 46080, v241
    v_add_u32 v241, 15360, v241
    s_lshl_b32 s39, s49, 16
    s_add_u32 s55, s55, s39
    s_lshl_b32 s56, s49, 12
    s_add_u32 s7, s55, s22
    s_lshl_b32 s39, s6, 19
    s_add_u32 s55, s55, s39
    v_mov_b32 v226, v0
    s_cmp_lt_u32 s38, 4
    s_waitcnt lgkmcnt(0)
    s_cbranch_scc1 L_noiss
    s_add_u32 m0, s56, 98304
    s_add_u32 s56, s56, 16384
    buffer_load_dwordx4 v240, s[20:23], s55 offen offset:0 lds
    buffer_load_dwordx4 v241, s[20:23], s55 offen offset:1024 lds
    buffer_load_dwordx4 v242, s[20:23], s55 offen offset:2048 lds
    buffer_load_dwordx4 v243, s[20:23], s55 offen offset:3072 lds
    s_and_b32 s56, s56, 0xffff
    s_add_u32 s55, s55, 0x40000
    s_cmp_ge_u32 s55, s7
    s_cselect_b32 s42, s22, 0
    s_sub_u32 s55, s55, s42
L_noiss:
    s_getpc_b64 s[4:5]
L_pc0:
    s_bfe_u32 s39, s2, 0x30003
    s_cmp_lg_u32 s39, s38
    s_cbranch_scc1 L_nocpf
    v_min_u32 v4, 0x92b8, v4
    v_mov_b32 v5, s5
    v_add_co_u32 v4, vcc, s4, v4
    s_nop 1
    v_addc_co_u32 v5, vcc, 0, v5, vcc
    global_load_dword v255, v[4:5], off
L_nocpf:
    s_cmp_lt_u32 s38, 4
    s_cbranch_scc1 L_qproj
    s_cmp_lt_u32 s38, 6
    s_cbranch_scc1 L_wq
    v_lshrrev_b32 v223, 3, v0
    s_lshl_b32 s40, s48, 3
    v_add_u32 v223, s40, v223
    v_lshrrev_b32 v224, 1, v223
    v_and_b32 v225, 7, v0
    v_xor_b32 v224, v224, v225
    v_lshlrev_b32 v224, 4, v224
    v_mul_u32_u24 v223, 1152, v223
    v_add_u32 v236, v223, v224
    s_mul_i32 s58, s37, 92160
    s_lshl_b32 s45, s48, 10
    s_lshl_b32 s6, s6, 7
    s_mov_b32 s10, 1474560
    s_mov_b32 s11, 0x20000
    s_add_u32 m0, s45, 0
    s_add_u32 s44, s58, s6
    s_add_u32 s6, s6, 128
    s_cmp_ge_u32 s6, 1152
    s_cselect_b32 s6, 0, s6
    s_add_u32 s41, s44, 0
    buffer_load_dwordx4 v236, s[8:11], s41 offen lds
    s_add_u32 m0, m0, 2048
    s_add_u32 s41, s44, 18432
    buffer_load_dwordx4 v236, s[8:11], s41 offen lds
    s_add_u32 m0, m0, 2048
    s_add_u32 s41, s44, 36864
    buffer_load_dwordx4 v236, s[8:11], s41 offen lds
    s_add_u32 m0, m0, 2048
    s_add_u32 s41, s44, 55296
    buffer_load_dwordx4 v236, s[8:11], s41 offen lds
    s_add_u32 m0, m0, 2048
    s_add_u32 s41, s44, 73728
    buffer_load_dwordx4 v236, s[8:11], s41 offen lds
    s_add_u32 m0, s45, 10240
    s_add_u32 s44, s58, s6
    s_add_u32 s6, s6, 128
    s_cmp_ge_u32 s6, 1152
    s_cselect_b32 s6, 0, s6
    s_add_u32 s41, s44, 0
    buffer_load_dwordx4 v236, s[8:11], s41 offen lds
    s_add_u32 m0, m0, 2048
    s_add_u32 s41, s44, 18432
    buffer_load_dwordx4 v236, s[8:11], s41 offen lds
    s_add_u32 m0, m0, 2048
    s_add_u32 s41, s44, 36864
    buffer_load_dwordx4 v236, s[8:11], s41 offen lds
    s_add_u32 m0, m0, 2048
    s_add_u32 s41, s44, 55296
    buffer_load_dwordx4 v236, s[8:11], s41 offen lds
    s_add_u32 m0, m0, 2048
    s_add_u32 s41, s44, 73728
    buffer_load_dwordx4 v236, s[8:11], s41 offen lds
    s_add_u32 m0, s45, 20480
    s_add_u32 s44, s58, s6
    s_add_u32 s6, s6, 128
    s_cmp_ge_u32 s6, 1152
    s_cselect_b32 s6, 0, s6
    s_add_u32 s41, s44, 0
    buffer_load_dwordx4 v236, s[8:11], s41 offen lds
    s_add_u32 m0, m0, 2048
    s_add_u32 s41, s44, 18432
    buffer_load_dwordx4 v236, s[8:11], s41 offen lds
    s_add_u32 m0, m0, 2048
    s_add_u32 s41, s44, 36864
    buffer_load_dwordx4 v236, s[8:11], s41 offen lds
    s_add_u32 m0, m0, 2048
    s_add_u32 s41, s44, 55296
    buffer_load_dwordx4 v236, s[8:11], s41 offen lds
    s_add_u32 m0, m0, 2048
    s_add_u32 s41, s44, 73728
    buffer_load_dwordx4 v236, s[8:11], s41 offen lds
    s_add_u32 m0, s56, 98304
    s_add_u32 s56, s56, 16384
    buffer_load_dwordx4 v240, s[20:23], s55 offen offset:0 lds
    buffer_load_dwordx4 v241, s[20:23], s55 offen offset:1024 lds
    buffer_load_dwordx4 v242, s[20:23], s55 offen offset:2048 lds
    buffer_load_dwordx4 v243, s[20:23], s55 offen offset:3072 lds
    s_and_b32 s56, s56, 0xffff
    s_add_u32 s55, s55, 0x40000
    s_cmp_ge_u32 s55, s7
    s_cselect_b32 s42, s22, 0
    s_sub_u32 s55, s55, s42
    s_lshl_b32 s39, s48, 3
    s_add_u32 s39, s39, 8
    s_load_dwordx2 s[12:13], s[0:1], s39
    s_load_dwordx2 s[24:25], s[0:1], 32
    s_load_dwordx2 s[32:33], s[0:1], 40
    s_load_dwordx2 s[16:17], s[0:1], 48
    s_load_dwordx2 s[28:29], s[0:1], 56
    s_mov_b32 s14, 67108864
    s_mov_b32 s15, 0x20000
    s_mov_b32 s26, 4718592
    s_mov_b32 s27, 0x20000
    s_mov_b32 s34, 1474560
    s_mov_b32 s35, 0x20000
    s_mov_b32 s18, 256
    s_mov_b32 s19, 0x20000
    s_mov_b32 s30, 268435456
    s_mov_b32 s31, 0x20000
    s_lshl_b32 s3, s37, 4
    s_add_u32 s3, s3, s36
    s_lshl_b32 s3, s3, 18
    s_lshr_b32 s60, s2, 3
    s_lshl_b32 s60, s60, 12
    s_waitcnt lgkmcnt(0)
    v_lshrrev_b32 v1, 4, v0
    v_and_b32 v2, 15, v0
    v_lshlrev_b32 v3, s48, v1
    v_xor_b32 v3, v3, v2
    v_lshlrev_b32 v3, 4, v3
    v_lshl_add_u32 v228, v1, 8, v3
    s_cmp_eq_u32 s48, 0
    s_mov_b32 s39, 128
    s_cselect_b32 s39, 64, s39
    v_xor_b32 v229, s39, v228
    s_mov_b32 s39, 0
    s_cselect_b32 s39, 128, s39
    v_xor_b32 v230, s39, v228
    s_mov_b32 s39, 128
    s_cselect_b32 s39, 192, s39
    v_xor_b32 v231, s39, v228
    v_lshrrev_b32 v223, 3, v226
    v_bfe_u32 v224, v226, 4, 2
    v_bfe_u32 v225, v226, 1, 2
    v_xor_b32 v224, v224, v225
    v_lshlrev_b32 v224, 5, v224
    v_and_b32 v225, 1, v226
    v_lshl_add_u32 v224, v225, 4, v224
    v_mul_u32_u24 v223, 1152, v223
    v_add_u32 v232, v223, v224
    v_add_u32 v233, 8192, v232
    v_add_u32 v234, 16384, v232
    v_add_u32 v235, 24576, v232
    s_mul_i32 s50, s36, 294912
    s_waitcnt vmcnt(14)
    s_barrier
    s_add_u32 m0, s56, 98304
    s_add_u32 s56, s56, 16384
    buffer_load_dwordx4 v240, s[20:23], s55 offen offset:0 lds
    buffer_load_dwordx4 v241, s[20:23], s55 offen offset:1024 lds
    buffer_load_dwordx4 v242, s[20:23], s55 offen offset:2048 lds
    buffer_load_dwordx4 v243, s[20:23], s55 offen offset:3072 lds
    s_and_b32 s56, s56, 0xffff
    s_add_u32 s55, s55, 0x40000
    s_cmp_ge_u32 s55, s7
    s_cselect_b32 s42, s22, 0
    s_sub_u32 s55, s55, s42
    s_add_u32 m0, s56, 98304
    s_add_u32 s56, s56, 16384
    buffer_load_dwordx4 v240, s[20:23], s55 offen offset:0 lds
    buffer_load_dwordx4 v241, s[20:23], s55 offen offset:1024 lds
    buffer_load_dwordx4 v242, s[20:23], s55 offen offset:2048 lds
    buffer_load_dwordx4 v243, s[20:23], s55 offen offset:3072 lds
    s_and_b32 s56, s56, 0xffff
    s_add_u32 s55, s55, 0x40000
    s_cmp_ge_u32 s55, s7
    s_cselect_b32 s42, s22, 0
    s_sub_u32 s55, s55, s42
    s_add_u32 m0, s45, 32768
    s_add_u32 s44, s58, s6
    s_add_u32 s6, s6, 128
    s_cmp_ge_u32 s6, 1152
    s_cselect_b32 s6, 0, s6
    s_add_u32 s41, s44, 0
    buffer_load_dwordx4 v236, s[8:11], s41 offen lds
    s_add_u32 m0, m0, 2048
    s_add_u32 s41, s44, 18432
    buffer_load_dwordx4 v236, s[8:11], s41 offen lds
    s_add_u32 m0, m0, 2048
    s_add_u32 s41, s44, 36864
    buffer_load_dwordx4 v236, s[8:11], s41 offen lds
    s_add_u32 m0, m0, 2048
    s_add_u32 s41, s44, 55296
    buffer_load_dwordx4 v236, s[8:11], s41 offen lds
    s_add_u32 m0, m0, 2048
    s_add_u32 s41, s44, 73728
    buffer_load_dwordx4 v236, s[8:11], s41 offen lds
    s_waitcnt vmcnt(13)
    s_barrier
    s_add_u32 m0, s56, 98304
    s_add_u32 s56, s56, 16384
    buffer_load_dwordx4 v240, s[20:23], s55 offen offset:0 lds
    buffer_load_dwordx4 v241, s[20:23], s55 offen offset:1024 lds
    buffer_load_dwordx4 v242, s[20:23], s55 offen offset:2048 lds
    buffer_load_dwordx4 v243, s[20:23], s55 offen offset:3072 lds
    s_and_b32 s56, s56, 0xffff
    s_add_u32 s55, s55, 0x40000
    s_cmp_ge_u32 s55, s7
    s_cselect_b32 s42, s22, 0
    s_sub_u32 s55, s55, s42
    s_add_u32 m0, s45, 43008
    s_add_u32 s44, s58, s6
    s_add_u32 s6, s6, 128
    s_cmp_ge_u32 s6, 1152
    s_cselect_b32 s6, 0, s6
    s_add_u32 s41, s44, 0
    buffer_load_dwordx4 v236, s[8:11], s41 offen lds
    s_add_u32 m0, m0, 2048
    s_add_u32 s41, s44, 18432
    buffer_load_dwordx4 v236, s[8:11], s41 offen lds
    s_add_u32 m0, m0, 2048
    s_add_u32 s41, s44, 36864
    buffer_load_dwordx4 v236, s[8:11], s41 offen lds
    s_add_u32 m0, m0, 2048
    s_add_u32 s41, s44, 55296
    buffer_load_dwordx4 v236, s[8:11], s41 offen lds
    s_add_u32 m0, m0, 2048
    s_add_u32 s41, s44, 73728
    buffer_load_dwordx4 v236, s[8:11], s41 offen lds
    s_waitcnt vmcnt(18)
    s_barrier
    s_add_u32 m0, s56, 98304
    s_add_u32 s56, s56, 16384
    buffer_load_dwordx4 v240, s[20:23], s55 offen offset:0 lds
    buffer_load_dwordx4 v241, s[20:23], s55 offen offset:1024 lds
    buffer_load_dwordx4 v242, s[20:23], s55 offen offset:2048 lds
    buffer_load_dwordx4 v243, s[20:23], s55 offen offset:3072 lds
    s_and_b32 s56, s56, 0xffff
    s_add_u32 s55, s55, 0x40000
    s_cmp_ge_u32 s55, s7
    s_cselect_b32 s42, s22, 0
    s_sub_u32 s55, s55, s42
    s_add_u32 m0, s45, 53248
    s_add_u32 s44, s58, s6
    s_add_u32 s6, s6, 128
    s_cmp_ge_u32 s6, 1152
    s_cselect_b32 s6, 0, s6
    s_add_u32 s41, s44, 0
    buffer_load_dwordx4 v236, s[8:11], s41 offen lds
    s_add_u32 m0, m0, 2048
    s_add_u32 s41, s44, 18432
    buffer_load_dwordx4 v236, s[8:11], s41 offen lds
    s_add_u32 m0, m0, 2048
    s_add_u32 s41, s44, 36864
    buffer_load_dwordx4 v236, s[8:11], s41 offen lds
    s_add_u32 m0, m0, 2048
    s_add_u32 s41, s44, 55296
    buffer_load_dwordx4 v236, s[8:11], s41 offen lds
    s_add_u32 m0, m0, 2048
    s_add_u32 s41, s44, 73728
    buffer_load_dwordx4 v236, s[8:11], s41 offen lds
    s_waitcnt vmcnt(23)
    s_barrier
    s_add_u32 m0, s56, 98304
    s_add_u32 s56, s56, 16384
    buffer_load_dwordx4 v240, s[20:23], s55 offen offset:0 lds
    buffer_load_dwordx4 v241, s[20:23], s55 offen offset:1024 lds
    buffer_load_dwordx4 v242, s[20:23], s55 offen offset:2048 lds
    buffer_load_dwordx4 v243, s[20:23], s55 offen offset:3072 lds
    s_and_b32 s56, s56, 0xffff
    s_add_u32 s55, s55, 0x40000
    s_cmp_ge_u32 s55, s7
    s_cselect_b32 s42, s22, 0
    s_sub_u32 s55, s55, s42
    s_add_u32 m0, s45, 65536
    s_add_u32 s44, s58, s6
    s_add_u32 s6, s6, 128
    s_cmp_ge_u32 s6, 1152
    s_cselect_b32 s6, 0, s6
    s_add_u32 s41, s44, 0
    buffer_load_dwordx4 v236, s[8:11], s41 offen lds
    s_add_u32 m0, m0, 2048
    s_add_u32 s41, s44, 18432
    buffer_load_dwordx4 v236, s[8:11], s41 offen lds
    s_add_u32 m0, m0, 2048
    s_add_u32 s41, s44, 36864
    buffer_load_dwordx4 v236, s[8:11], s41 offen lds
    s_add_u32 m0, m0, 2048
    s_add_u32 s41, s44, 55296
    buffer_load_dwordx4 v236, s[8:11], s41 offen lds
    s_add_u32 m0, m0, 2048
    s_add_u32 s41, s44, 73728
    buffer_load_dwordx4 v236, s[8:11], s41 offen lds
    s_waitcnt vmcnt(23)
    s_barrier
    s_add_u32 m0, s56, 98304
    s_add_u32 s56, s56, 16384
    buffer_load_dwordx4 v240, s[20:23], s55 offen offset:0 lds
    buffer_load_dwordx4 v241, s[20:23], s55 offen offset:1024 lds
    buffer_load_dwordx4 v242, s[20:23], s55 offen offset:2048 lds
    buffer_load_dwordx4 v243, s[20:23], s55 offen offset:3072 lds
    s_and_b32 s56, s56, 0xffff
    s_add_u32 s55, s55, 0x40000
    s_cmp_ge_u32 s55, s7
    s_cselect_b32 s42, s22, 0
    s_sub_u32 s55, s55, s42
    s_add_u32 m0, s45, 75776
    s_add_u32 s44, s58, s6
    s_add_u32 s6, s6, 128
    s_cmp_ge_u32 s6, 1152
    s_cselect_b32 s6, 0, s6
    s_add_u32 s41, s44, 0
    buffer_load_dwordx4 v236, s[8:11], s41 offen lds
    s_add_u32 m0, m0, 2048
    s_add_u32 s41, s44, 18432
    buffer_load_dwordx4 v236, s[8:11], s41 offen lds
    s_add_u32 m0, m0, 2048
    s_add_u32 s41, s44, 36864
    buffer_load_dwordx4 v236, s[8:11], s41 offen lds
    s_add_u32 m0, m0, 2048
    s_add_u32 s41, s44, 55296
    buffer_load_dwordx4 v236, s[8:11], s41 offen lds
    s_add_u32 m0, m0, 2048
    s_add_u32 s41, s44, 73728
    buffer_load_dwordx4 v236, s[8:11], s41 offen lds
    s_waitcnt vmcnt(23)
    s_barrier
    s_add_u32 m0, s56, 98304
    s_add_u32 s56, s56, 16384
    buffer_load_dwordx4 v240, s[20:23], s55 offen offset:0 lds
    buffer_load_dwordx4 v241, s[20:23], s55 offen offset:1024 lds
    buffer_load_dwordx4 v242, s[20:23], s55 offen offset:2048 lds
    buffer_load_dwordx4 v243, s[20:23], s55 offen offset:3072 lds
    s_and_b32 s56, s56, 0xffff
    s_add_u32 s55, s55, 0x40000
    s_cmp_ge_u32 s55, s7
    s_cselect_b32 s42, s22, 0
    s_sub_u32 s55, s55, s42
    s_add_u32 m0, s45, 86016
    s_add_u32 s44, s58, s6
    s_add_u32 s6, s6, 128
    s_cmp_ge_u32 s6, 1152
    s_cselect_b32 s6, 0, s6
    s_add_u32 s41, s44, 0
    buffer_load_dwordx4 v236, s[8:11], s41 offen lds
    s_add_u32 m0, m0, 2048
    s_add_u32 s41, s44, 18432
    buffer_load_dwordx4 v236, s[8:11], s41 offen lds
    s_add_u32 m0, m0, 2048
    s_add_u32 s41, s44, 36864
    buffer_load_dwordx4 v236, s[8:11], s41 offen lds
    s_add_u32 m0, m0, 2048
    s_add_u32 s41, s44, 55296
    buffer_load_dwordx4 v236, s[8:11], s41 offen lds
    s_add_u32 m0, m0, 2048
    s_add_u32 s41, s44, 73728
    buffer_load_dwordx4 v236, s[8:11], s41 offen lds
    s_waitcnt vmcnt(23)
    s_barrier
    s_mul_i32 s39, s48, 147456
    s_add_u32 s50, s50, s39
    s_lshl_b32 s59, s48, 14
    v_lshlrev_b32 v237, 4, v226
    v_add_u32 v237, s59, v237
    v_and_b32 v223, 7, v226
    v_mul_u32_u24 v227, 1152, v223
    v_and_b32 v223, 24, v226
    v_mov_b32 v224, 0x07050302
    v_lshrrev_b32 v223, v223, v224
    v_and_b32 v223, 15, v223
    v_lshl_add_u32 v227, v223, 7, v227
    s_mul_i32 s39, s37, 9216
    s_add_u32 s52, s50, s39
    s_lshl_b32 s51, s37, 3
    s_cmp_eq_u32 s48, 1
    s_cbranch_scc1 L_kv_v
    s_add_u32 m0, s56, 98304
    s_add_u32 s56, s56, 16384
    buffer_load_dwordx4 v240, s[20:23], s55 offen offset:0 lds
    buffer_load_dwordx4 v241, s[20:23], s55 offen offset:1024 lds
    buffer_load_dwordx4 v242, s[20:23], s55 offen offset:2048 lds
    buffer_load_dwordx4 v243, s[20:23], s55 offen offset:3072 lds
    s_and_b32 s56, s56, 0xffff
    s_add_u32 s55, s55, 0x40000
    s_cmp_ge_u32 s55, s7
    s_cselect_b32 s42, s22, 0
    s_sub_u32 s55, s55, s42
    s_waitcnt vmcnt(18)
    s_barrier
    s_add_u32 m0, s56, 98304
    s_add_u32 s56, s56, 16384
    buffer_load_dwordx4 v240, s[20:23], s55 offen offset:0 lds
    buffer_load_dwordx4 v241, s[20:23], s55 offen offset:1024 lds
    buffer_load_dwordx4 v242, s[20:23], s55 offen offset:2048 lds
    buffer_load_dwordx4 v243, s[20:23], s55 offen offset:3072 lds
    s_and_b32 s56, s56, 0xffff
    s_add_u32 s55, s55, 0x40000
    s_cmp_ge_u32 s55, s7
    s_cselect_b32 s42, s22, 0
    s_sub_u32 s55, s55, s42
    s_waitcnt vmcnt(13)
    s_barrier
    s_add_u32 m0, s56, 98304
    s_add_u32 s56, s56, 16384
    buffer_load_dwordx4 v240, s[20:23], s55 offen offset:0 lds
    buffer_load_dwordx4 v241, s[20:23], s55 offen offset:1024 lds
    buffer_load_dwordx4 v242, s[20:23], s55 offen offset:2048 lds
    buffer_load_dwordx4 v243, s[20:23], s55 offen offset:3072 lds
    s_and_b32 s56, s56, 0xffff
    s_add_u32 s55, s55, 0x40000
    s_cmp_ge_u32 s55, s7
    s_cselect_b32 s42, s22, 0
    s_sub_u32 s55, s55, s42
    s_waitcnt vmcnt(8)
    s_barrier
    s_add_u32 m0, s56, 98304
    s_add_u32 s56, s56, 16384
    buffer_load_dwordx4 v240, s[20:23], s55 offen offset:0 lds
    buffer_load_dwordx4 v241, s[20:23], s55 offen offset:1024 lds
    buffer_load_dwordx4 v242, s[20:23], s55 offen offset:2048 lds
    buffer_load_dwordx4 v243, s[20:23], s55 offen offset:3072 lds
    s_and_b32 s56, s56, 0xffff
    s_add_u32 s55, s55, 0x40000
    s_cmp_ge_u32 s55, s7
    s_cselect_b32 s42, s22, 0
    s_sub_u32 s55, s55, s42
    s_waitcnt vmcnt(8)
    s_barrier
    s_add_u32 m0, s56, 98304
    s_add_u32 s56, s56, 16384
    buffer_load_dwordx4 v240, s[20:23], s55 offen offset:0 lds
    buffer_load_dwordx4 v241, s[20:23], s55 offen offset:1024 lds
    buffer_load_dwordx4 v242, s[20:23], s55 offen offset:2048 lds
    buffer_load_dwordx4 v243, s[20:23], s55 offen offset:3072 lds
    s_and_b32 s56, s56, 0xffff
    s_add_u32 s55, s55, 0x40000
    s_cmp_ge_u32 s55, s7
    s_cselect_b32 s42, s22, 0
    s_sub_u32 s55, s55, s42
    s_mov_b32 m0, 0
    s_add_u32 s61, s60, 0
    s_and_b32 s61, s61, 0x3ffff
    s_or_b32 s61, s61, s3
    buffer_load_dwordx4 v228, s[12:15], s61 offen offset:0 nt lds
    buffer_load_dwordx4 v229, s[12:15], s61 offen offset:1024 nt lds
    buffer_load_dwordx4 v230, s[12:15], s61 offen offset:2048 nt lds
    buffer_load_dwordx4 v231, s[12:15], s61 offen offset:3072 nt lds
    s_waitcnt vmcnt(12)
    s_barrier
    s_add_u32 m0, s56, 98304
    s_add_u32 s56, s56, 16384
    buffer_load_dwordx4 v240, s[20:23], s55 offen offset:0 lds
    buffer_load_dwordx4 v241, s[20:23], s55 offen offset:1024 lds
    buffer_load_dwordx4 v242, s[20:23], s55 offen offset:2048 lds
    buffer_load_dwordx4 v243, s[20:23], s55 offen offset:3072 lds
    s_and_b32 s56, s56, 0xffff
    s_add_u32 s55, s55, 0x40000
    s_cmp_ge_u32 s55, s7
    s_cselect_b32 s42, s22, 0
    s_sub_u32 s55, s55, s42
    s_mov_b32 m0, 4096
    s_add_u32 s61, s60, 4096
    s_and_b32 s61, s61, 0x3ffff
    s_or_b32 s61, s61, s3
    buffer_load_dwordx4 v228, s[12:15], s61 offen offset:0 nt lds
    buffer_load_dwordx4 v229, s[12:15], s61 offen offset:1024 nt lds
    buffer_load_dwordx4 v230, s[12:15], s61 offen offset:2048 nt lds
    buffer_load_dwordx4 v231, s[12:15], s61 offen offset:3072 nt lds
    s_waitcnt vmcnt(16)
    s_barrier
    s_add_u32 m0, s56, 98304
    s_add_u32 s56, s56, 16384
    buffer_load_dwordx4 v240, s[20:23], s55 offen offset:0 lds
    buffer_load_dwordx4 v241, s[20:23], s55 offen offset:1024 lds
    buffer_load_dwordx4 v242, s[20:23], s55 offen offset:2048 lds
    buffer_load_dwordx4 v243, s[20:23], s55 offen offset:3072 lds
    s_and_b32 s56, s56, 0xffff
    s_add_u32 s55, s55, 0x40000
    s_cmp_ge_u32 s55, s7
    s_cselect_b32 s42, s22, 0
    s_sub_u32 s55, s55, s42
    s_mov_b32 m0, 8192
    s_add_u32 s61, s60, 8192
    s_and_b32 s61, s61, 0x3ffff
    s_or_b32 s61, s61, s3
    buffer_load_dwordx4 v228, s[12:15], s61 offen offset:0 nt lds
    buffer_load_dwordx4 v229, s[12:15], s61 offen offset:1024 nt lds
    buffer_load_dwordx4 v230, s[12:15], s61 offen offset:2048 nt lds
    buffer_load_dwordx4 v231, s[12:15], s61 offen offset:3072 nt lds
    s_waitcnt vmcnt(20)
    s_barrier
    s_add_u32 m0, s56, 98304
    s_add_u32 s56, s56, 16384
    buffer_load_dwordx4 v240, s[20:23], s55 offen offset:0 lds
    buffer_load_dwordx4 v241, s[20:23], s55 offen offset:1024 lds
    buffer_load_dwordx4 v242, s[20:23], s55 offen offset:2048 lds
    buffer_load_dwordx4 v243, s[20:23], s55 offen offset:3072 lds
    s_and_b32 s56, s56, 0xffff
    s_add_u32 s55, s55, 0x40000
    s_cmp_ge_u32 s55, s7
    s_cselect_b32 s42, s22, 0
    s_sub_u32 s55, s55, s42
    s_mov_b32 m0, 12288
    s_add_u32 s61, s60, 12288
    s_and_b32 s61, s61, 0x3ffff
    s_or_b32 s61, s61, s3
    buffer_load_dwordx4 v228, s[12:15], s61 offen offset:0 nt lds
    buffer_load_dwordx4 v229, s[12:15], s61 offen offset:1024 nt lds
    buffer_load_dwordx4 v230, s[12:15], s61 offen offset:2048 nt lds
    buffer_load_dwordx4 v231, s[12:15], s61 offen offset:3072 nt lds
    s_waitcnt vmcnt(20)
    s_barrier
    s_add_u32 m0, s56, 98304
    s_add_u32 s56, s56, 16384
    buffer_load_dwordx4 v240, s[20:23], s55 offen offset:0 lds
    buffer_load_dwordx4 v241, s[20:23], s55 offen offset:1024 lds
    buffer_load_dwordx4 v242, s[20:23], s55 offen offset:2048 lds
    buffer_load_dwordx4 v243, s[20:23], s55 offen offset:3072 lds
    s_and_b32 s56, s56, 0xffff
    s_add_u32 s55, s55, 0x40000
    s_cmp_ge_u32 s55, s7
    s_cselect_b32 s42, s22, 0
    s_sub_u32 s55, s55, s42
    s_mov_b32 m0, 32768
    s_add_u32 s61, s60, 16384
    s_and_b32 s61, s61, 0x3ffff
    s_or_b32 s61, s61, s3
    buffer_load_dwordx4 v228, s[12:15], s61 offen offset:0 nt lds
    buffer_load_dwordx4 v229, s[12:15], s61 offen offset:1024 nt lds
    buffer_load_dwordx4 v230, s[12:15], s61 offen offset:2048 nt lds
    buffer_load_dwordx4 v231, s[12:15], s61 offen offset:3072 nt lds
    s_waitcnt vmcnt(20)
    s_barrier
    s_mov_b32 m0, 36864
    s_add_u32 s61, s60, 20480
    s_and_b32 s61, s61, 0x3ffff
    s_or_b32 s61, s61, s3
    buffer_load_dwordx4 v228, s[12:15], s61 offen offset:0 nt lds
    buffer_load_dwordx4 v229, s[12:15], s61 offen offset:1024 nt lds
    buffer_load_dwordx4 v230, s[12:15], s61 offen offset:2048 nt lds
    buffer_load_dwordx4 v231, s[12:15], s61 offen offset:3072 nt lds
    s_waitcnt vmcnt(16)
    s_barrier
    s_mov_b32 m0, 40960
    s_add_u32 s61, s60, 24576
    s_and_b32 s61, s61, 0x3ffff
    s_or_b32 s61, s61, s3
    buffer_load_dwordx4 v228, s[12:15], s61 offen offset:0 nt lds
    buffer_load_dwordx4 v229, s[12:15], s61 offen offset:1024 nt lds
    buffer_load_dwordx4 v230, s[12:15], s61 offen offset:2048 nt lds
    buffer_load_dwordx4 v231, s[12:15], s61 offen offset:3072 nt lds
    s_waitcnt vmcnt(12)
    s_barrier
    s_mov_b32 m0, 45056
    s_add_u32 s61, s60, 28672
    s_and_b32 s61, s61, 0x3ffff
    s_or_b32 s61, s61, s3
    buffer_load_dwordx4 v228, s[12:15], s61 offen offset:0 nt lds
    buffer_load_dwordx4 v229, s[12:15], s61 offen offset:1024 nt lds
    buffer_load_dwordx4 v230, s[12:15], s61 offen offset:2048 nt lds
    buffer_load_dwordx4 v231, s[12:15], s61 offen offset:3072 nt lds
    s_barrier
    s_mov_b32 m0, 65536
    s_add_u32 s61, s60, 32768
    s_and_b32 s61, s61, 0x3ffff
    s_or_b32 s61, s61, s3
    buffer_load_dwordx4 v228, s[12:15], s61 offen offset:0 nt lds
    buffer_load_dwordx4 v229, s[12:15], s61 offen offset:1024 nt lds
    buffer_load_dwordx4 v230, s[12:15], s61 offen offset:2048 nt lds
    buffer_load_dwordx4 v231, s[12:15], s61 offen offset:3072 nt lds
    s_mov_b32 m0, 69632
    s_add_u32 s61, s60, 36864
    s_and_b32 s61, s61, 0x3ffff
    s_or_b32 s61, s61, s3
    buffer_load_dwordx4 v228, s[12:15], s61 offen offset:0 nt lds
    buffer_load_dwordx4 v229, s[12:15], s61 offen offset:1024 nt lds
    buffer_load_dwordx4 v230, s[12:15], s61 offen offset:2048 nt lds
    buffer_load_dwordx4 v231, s[12:15], s61 offen offset:3072 nt lds
    s_barrier
    s_mov_b32 m0, 73728
    s_add_u32 s61, s60, 40960
    s_and_b32 s61, s61, 0x3ffff
    s_or_b32 s61, s61, s3
    buffer_load_dwordx4 v228, s[12:15], s61 offen offset:0 nt lds
    buffer_load_dwordx4 v229, s[12:15], s61 offen offset:1024 nt lds
    buffer_load_dwordx4 v230, s[12:15], s61 offen offset:2048 nt lds
    buffer_load_dwordx4 v231, s[12:15], s61 offen offset:3072 nt lds
    s_mov_b32 m0, 77824
    s_add_u32 s61, s60, 45056
    s_and_b32 s61, s61, 0x3ffff
    s_or_b32 s61, s61, s3
    buffer_load_dwordx4 v228, s[12:15], s61 offen offset:0 nt lds
    buffer_load_dwordx4 v229, s[12:15], s61 offen offset:1024 nt lds
    buffer_load_dwordx4 v230, s[12:15], s61 offen offset:2048 nt lds
    buffer_load_dwordx4 v231, s[12:15], s61 offen offset:3072 nt lds
    s_barrier
    s_waitcnt vmcnt(16)
    s_barrier
    s_mov_b32 m0, 0
    s_add_u32 s61, s60, 49152
    s_and_b32 s61, s61, 0x3ffff
    s_or_b32 s61, s61, s3
    s_waitcnt vmcnt(10)
    buffer_load_dwordx4 v228, s[12:15], s61 offen offset:0 nt lds
    s_waitcnt vmcnt(10)
    buffer_load_dwordx4 v229, s[12:15], s61 offen offset:1024 nt lds
    s_waitcnt vmcnt(10)
    buffer_load_dwordx4 v230, s[12:15], s61 offen offset:2048 nt lds
    s_waitcnt vmcnt(10)
    buffer_load_dwordx4 v231, s[12:15], s61 offen offset:3072 nt lds
    s_add_u32 s40, s50, 512
    buffer_load_dwordx4 v[16:19], v232, s[24:27], s40 offen offset:0
    s_mov_b32 m0, 4096
    s_add_u32 s61, s60, 53248
    s_and_b32 s61, s61, 0x3ffff
    s_or_b32 s61, s61, s3
    s_waitcnt vmcnt(10)
    buffer_load_dwordx4 v228, s[12:15], s61 offen offset:0 nt lds
    s_waitcnt vmcnt(10)
    buffer_load_dwordx4 v229, s[12:15], s61 offen offset:1024 nt lds
    s_waitcnt vmcnt(10)
    buffer_load_dwordx4 v230, s[12:15], s61 offen offset:2048 nt lds
    s_waitcnt vmcnt(10)
    buffer_load_dwordx4 v231, s[12:15], s61 offen offset:3072 nt lds
    buffer_load_dwordx4 v[20:23], v233, s[24:27], s40 offen offset:1024
    s_mov_b32 m0, 8192
    s_add_u32 s61, s60, 57344
    s_and_b32 s61, s61, 0x3ffff
    s_or_b32 s61, s61, s3
    s_waitcnt vmcnt(10)
    buffer_load_dwordx4 v228, s[12:15], s61 offen offset:0 nt lds
    s_waitcnt vmcnt(10)
    buffer_load_dwordx4 v229, s[12:15], s61 offen offset:1024 nt lds
    s_waitcnt vmcnt(10)
    buffer_load_dwordx4 v230, s[12:15], s61 offen offset:2048 nt lds
    s_waitcnt vmcnt(10)
    buffer_load_dwordx4 v231, s[12:15], s61 offen offset:3072 nt lds
    buffer_load_dwordx4 v[24:27], v234, s[24:27], s40 offen offset:2048
    s_mov_b32 m0, 12288
    s_add_u32 s61, s60, 61440
    s_and_b32 s61, s61, 0x3ffff
    s_or_b32 s61, s61, s3
    s_waitcnt vmcnt(10)
    buffer_load_dwordx4 v228, s[12:15], s61 offen offset:0 nt lds
    s_waitcnt vmcnt(10)
    buffer_load_dwordx4 v229, s[12:15], s61 offen offset:1024 nt lds
    s_waitcnt vmcnt(10)
    buffer_load_dwordx4 v230, s[12:15], s61 offen offset:2048 nt lds
    s_waitcnt vmcnt(18)
    s_barrier
    s_waitcnt vmcnt(10)
    buffer_load_dwordx4 v231, s[12:15], s61 offen offset:3072 nt lds
    buffer_load_dwordx4 v[28:31], v235, s[24:27], s40 offen offset:3072
    s_mov_b32 m0, 32768
    s_add_u32 s61, s60, 65536
    s_and_b32 s61, s61, 0x3ffff
    s_or_b32 s61, s61, s3
    s_waitcnt vmcnt(10)
    buffer_load_dwordx4 v228, s[12:15], s61 offen offset:0 nt lds
    s_waitcnt vmcnt(10)
    buffer_load_dwordx4 v229, s[12:15], s61 offen offset:1024 nt lds
    s_waitcnt vmcnt(10)
    buffer_load_dwordx4 v230, s[12:15], s61 offen offset:2048 nt lds
    s_waitcnt vmcnt(10)
    buffer_load_dwordx4 v231, s[12:15], s61 offen offset:3072 nt lds
    s_add_u32 s40, s50, 37376
    buffer_load_dwordx4 v[32:35], v232, s[24:27], s40 offen offset:0
    s_mov_b32 m0, 36864
    s_add_u32 s61, s60, 69632
    s_and_b32 s61, s61, 0x3ffff
    s_or_b32 s61, s61, s3
    s_waitcnt vmcnt(10)
    buffer_load_dwordx4 v228, s[12:15], s61 offen offset:0 nt lds
    s_waitcnt vmcnt(10)
    buffer_load_dwordx4 v229, s[12:15], s61 offen offset:1024 nt lds
    s_waitcnt vmcnt(10)
    buffer_load_dwordx4 v230, s[12:15], s61 offen offset:2048 nt lds
    s_waitcnt vmcnt(10)
    buffer_load_dwordx4 v231, s[12:15], s61 offen offset:3072 nt lds
    buffer_load_dwordx4 v[36:39], v233, s[24:27], s40 offen offset:1024
    s_mov_b32 m0, 40960
    s_add_u32 s61, s60, 73728
    s_and_b32 s61, s61, 0x3ffff
    s_or_b32 s61, s61, s3
    s_waitcnt vmcnt(10)
    buffer_load_dwordx4 v228, s[12:15], s61 offen offset:0 nt lds
    s_waitcnt vmcnt(10)
    buffer_load_dwordx4 v229, s[12:15], s61 offen offset:1024 nt lds
    s_waitcnt vmcnt(10)
    buffer_load_dwordx4 v230, s[12:15], s61 offen offset:2048 nt lds
    s_waitcnt vmcnt(10)
    buffer_load_dwordx4 v231, s[12:15], s61 offen offset:3072 nt lds
    buffer_load_dwordx4 v[40:43], v234, s[24:27], s40 offen offset:2048
    s_mov_b32 m0, 45056
    s_add_u32 s61, s60, 77824
    s_and_b32 s61, s61, 0x3ffff
    s_or_b32 s61, s61, s3
    s_waitcnt vmcnt(10)
    buffer_load_dwordx4 v228, s[12:15], s61 offen offset:0 nt lds
    s_waitcnt vmcnt(10)
    buffer_load_dwordx4 v229, s[12:15], s61 offen offset:1024 nt lds
    s_waitcnt vmcnt(18)
    s_barrier
    s_waitcnt vmcnt(10)
    buffer_load_dwordx4 v230, s[12:15], s61 offen offset:2048 nt lds
    s_waitcnt vmcnt(10)
    buffer_load_dwordx4 v231, s[12:15], s61 offen offset:3072 nt lds
    buffer_load_dwordx4 v[44:47], v235, s[24:27], s40 offen offset:3072
    s_mov_b32 m0, 65536
    s_add_u32 s61, s60, 81920
    s_and_b32 s61, s61, 0x3ffff
    s_or_b32 s61, s61, s3
    s_waitcnt vmcnt(10)
    buffer_load_dwordx4 v228, s[12:15], s61 offen offset:0 nt lds
    s_waitcnt vmcnt(10)
    buffer_load_dwordx4 v229, s[12:15], s61 offen offset:1024 nt lds
    s_waitcnt vmcnt(10)
    buffer_load_dwordx4 v230, s[12:15], s61 offen offset:2048 nt lds
    s_waitcnt vmcnt(10)
    buffer_load_dwordx4 v231, s[12:15], s61 offen offset:3072 nt lds
    s_add_u32 s40, s50, 74240
    buffer_load_dwordx4 v[48:51], v232, s[24:27], s40 offen offset:0
    s_mov_b32 m0, 69632
    s_add_u32 s61, s60, 86016
    s_and_b32 s61, s61, 0x3ffff
    s_or_b32 s61, s61, s3
    s_waitcnt vmcnt(10)
    buffer_load_dwordx4 v228, s[12:15], s61 offen offset:0 nt lds
    s_waitcnt vmcnt(10)
    buffer_load_dwordx4 v229, s[12:15], s61 offen offset:1024 nt lds
    s_waitcnt vmcnt(10)
    buffer_load_dwordx4 v230, s[12:15], s61 offen offset:2048 nt lds
    s_waitcnt vmcnt(10)
    buffer_load_dwordx4 v231, s[12:15], s61 offen offset:3072 nt lds
    buffer_load_dwordx4 v[52:55], v233, s[24:27], s40 offen offset:1024
    s_mov_b32 m0, 73728
    s_add_u32 s61, s60, 90112
    s_and_b32 s61, s61, 0x3ffff
    s_or_b32 s61, s61, s3
    s_waitcnt vmcnt(10)
    buffer_load_dwordx4 v228, s[12:15], s61 offen offset:0 nt lds
    s_waitcnt vmcnt(10)
    buffer_load_dwordx4 v229, s[12:15], s61 offen offset:1024 nt lds
    s_waitcnt vmcnt(10)
    buffer_load_dwordx4 v230, s[12:15], s61 offen offset:2048 nt lds
    s_waitcnt vmcnt(10)
    buffer_load_dwordx4 v231, s[12:15], s61 offen offset:3072 nt lds
    buffer_load_dwordx4 v[56:59], v234, s[24:27], s40 offen offset:2048
    s_mov_b32 m0, 77824
    s_add_u32 s61, s60, 94208
    s_and_b32 s61, s61, 0x3ffff
    s_or_b32 s61, s61, s3
    s_waitcnt vmcnt(10)
    buffer_load_dwordx4 v228, s[12:15], s61 offen offset:0 nt lds
    s_waitcnt vmcnt(17)
    s_barrier
    s_waitcnt vmcnt(10)
    buffer_load_dwordx4 v229, s[12:15], s61 offen offset:1024 nt lds
    s_waitcnt vmcnt(10)
    buffer_load_dwordx4 v230, s[12:15], s61 offen offset:2048 nt lds
    s_waitcnt vmcnt(10)
    buffer_load_dwordx4 v231, s[12:15], s61 offen offset:3072 nt lds
    buffer_load_dwordx4 v[60:63], v235, s[24:27], s40 offen offset:3072
    s_mov_b32 m0, 0
    s_add_u32 s61, s60, 98304
    s_and_b32 s61, s61, 0x3ffff
    s_or_b32 s61, s61, s3
    s_waitcnt vmcnt(10)
    buffer_load_dwordx4 v228, s[12:15], s61 offen offset:0 nt lds
    s_waitcnt vmcnt(10)
    buffer_load_dwordx4 v229, s[12:15], s61 offen offset:1024 nt lds
    s_waitcnt vmcnt(10)
    buffer_load_dwordx4 v230, s[12:15], s61 offen offset:2048 nt lds
    s_waitcnt vmcnt(10)
    buffer_load_dwordx4 v231, s[12:15], s61 offen offset:3072 nt lds
    s_add_u32 s40, s50, 111104
    buffer_load_dwordx4 v[64:67], v232, s[24:27], s40 offen offset:0
    s_mov_b32 m0, 4096
    s_add_u32 s61, s60, 102400
    s_and_b32 s61, s61, 0x3ffff
    s_or_b32 s61, s61, s3
    s_waitcnt vmcnt(10)
    buffer_load_dwordx4 v228, s[12:15], s61 offen offset:0 nt lds
    s_waitcnt vmcnt(10)
    buffer_load_dwordx4 v229, s[12:15], s61 offen offset:1024 nt lds
    s_waitcnt vmcnt(10)
    buffer_load_dwordx4 v230, s[12:15], s61 offen offset:2048 nt lds
    s_waitcnt vmcnt(10)
    buffer_load_dwordx4 v231, s[12:15], s61 offen offset:3072 nt lds
    buffer_load_dwordx4 v[68:71], v233, s[24:27], s40 offen offset:1024
    s_mov_b32 m0, 8192
    s_add_u32 s61, s60, 106496
    s_and_b32 s61, s61, 0x3ffff
    s_or_b32 s61, s61, s3
    s_waitcnt vmcnt(10)
    buffer_load_dwordx4 v228, s[12:15], s61 offen offset:0 nt lds
    s_waitcnt vmcnt(10)
    buffer_load_dwordx4 v229, s[12:15], s61 offen offset:1024 nt lds
    s_waitcnt vmcnt(10)
    buffer_load_dwordx4 v230, s[12:15], s61 offen offset:2048 nt lds
    s_waitcnt vmcnt(10)
    buffer_load_dwordx4 v231, s[12:15], s61 offen offset:3072 nt lds
    buffer_load_dwordx4 v[72:75], v234, s[24:27], s40 offen offset:2048
    s_waitcnt vmcnt(16)
    s_barrier
    s_mov_b32 m0, 12288
    s_add_u32 s61, s60, 110592
    s_and_b32 s61, s61, 0x3ffff
    s_or_b32 s61, s61, s3
    s_waitcnt vmcnt(10)
    buffer_load_dwordx4 v228, s[12:15], s61 offen offset:0 nt lds
    s_waitcnt vmcnt(10)
    buffer_load_dwordx4 v229, s[12:15], s61 offen offset:1024 nt lds
    s_waitcnt vmcnt(10)
    buffer_load_dwordx4 v230, s[12:15], s61 offen offset:2048 nt lds
    s_waitcnt vmcnt(10)
    buffer_load_dwordx4 v231, s[12:15], s61 offen offset:3072 nt lds
    buffer_load_dwordx4 v[76:79], v235, s[24:27], s40 offen offset:3072
    s_mov_b32 m0, 32768
    s_add_u32 s61, s60, 114688
    s_and_b32 s61, s61, 0x3ffff
    s_or_b32 s61, s61, s3
    s_waitcnt vmcnt(10)
    buffer_load_dwordx4 v228, s[12:15], s61 offen offset:0 nt lds
    s_waitcnt vmcnt(10)
    buffer_load_dwordx4 v229, s[12:15], s61 offen offset:1024 nt lds
    s_waitcnt vmcnt(10)
    buffer_load_dwordx4 v230, s[12:15], s61 offen offset:2048 nt lds
    s_waitcnt vmcnt(10)
    buffer_load_dwordx4 v231, s[12:15], s61 offen offset:3072 nt lds
    s_add_u32 s40, s50, 768
    buffer_load_dwordx4 v[80:83], v232, s[24:27], s40 offen offset:0
    s_mov_b32 m0, 36864
    s_add_u32 s61, s60, 118784
    s_and_b32 s61, s61, 0x3ffff
    s_or_b32 s61, s61, s3
    s_waitcnt vmcnt(10)
    buffer_load_dwordx4 v228, s[12:15], s61 offen offset:0 nt lds
    s_waitcnt vmcnt(10)
    buffer_load_dwordx4 v229, s[12:15], s61 offen offset:1024 nt lds
    s_waitcnt vmcnt(10)
    buffer_load_dwordx4 v230, s[12:15], s61 offen offset:2048 nt lds
    s_waitcnt vmcnt(10)
    buffer_load_dwordx4 v231, s[12:15], s61 offen offset:3072 nt lds
    buffer_load_dwordx4 v[84:87], v233, s[24:27], s40 offen offset:1024
    s_mov_b32 m0, 40960
    s_add_u32 s61, s60, 122880
    s_and_b32 s61, s61, 0x3ffff
    s_or_b32 s61, s61, s3
    s_waitcnt vmcnt(10)
    buffer_load_dwordx4 v228, s[12:15], s61 offen offset:0 nt lds
    s_waitcnt vmcnt(10)
    buffer_load_dwordx4 v229, s[12:15], s61 offen offset:1024 nt lds
    s_waitcnt vmcnt(10)
    buffer_load_dwordx4 v230, s[12:15], s61 offen offset:2048 nt lds
    s_waitcnt vmcnt(14)
    s_barrier
    s_waitcnt vmcnt(10)
    buffer_load_dwordx4 v231, s[12:15], s61 offen offset:3072 nt lds
    buffer_load_dwordx4 v[88:91], v234, s[24:27], s40 offen offset:2048
    s_mov_b32 m0, 45056
    s_add_u32 s61, s60, 126976
    s_and_b32 s61, s61, 0x3ffff
    s_or_b32 s61, s61, s3
    s_waitcnt vmcnt(10)
    buffer_load_dwordx4 v228, s[12:15], s61 offen offset:0 nt lds
    s_waitcnt vmcnt(10)
    buffer_load_dwordx4 v229, s[12:15], s61 offen offset:1024 nt lds
    s_waitcnt vmcnt(10)
    buffer_load_dwordx4 v230, s[12:15], s61 offen offset:2048 nt lds
    s_waitcnt vmcnt(10)
    buffer_load_dwordx4 v231, s[12:15], s61 offen offset:3072 nt lds
    buffer_load_dwordx4 v[92:95], v235, s[24:27], s40 offen offset:3072
    s_mov_b32 m0, 65536
    s_add_u32 s61, s60, 131072
    s_and_b32 s61, s61, 0x3ffff
    s_or_b32 s61, s61, s3
    s_waitcnt vmcnt(10)
    buffer_load_dwordx4 v228, s[12:15], s61 offen offset:0 nt lds
    s_waitcnt vmcnt(10)
    buffer_load_dwordx4 v229, s[12:15], s61 offen offset:1024 nt lds
    s_waitcnt vmcnt(10)
    buffer_load_dwordx4 v230, s[12:15], s61 offen offset:2048 nt lds
    s_waitcnt vmcnt(10)
    buffer_load_dwordx4 v231, s[12:15], s61 offen offset:3072 nt lds
    s_add_u32 s40, s50, 37632
    buffer_load_dwordx4 v[96:99], v232, s[24:27], s40 offen offset:0
    s_mov_b32 m0, 69632
    s_add_u32 s61, s60, 135168
    s_and_b32 s61, s61, 0x3ffff
    s_or_b32 s61, s61, s3
    s_waitcnt vmcnt(10)
    buffer_load_dwordx4 v228, s[12:15], s61 offen offset:0 nt lds
    s_waitcnt vmcnt(10)
    buffer_load_dwordx4 v229, s[12:15], s61 offen offset:1024 nt lds
    s_waitcnt vmcnt(10)
    buffer_load_dwordx4 v230, s[12:15], s61 offen offset:2048 nt lds
    s_waitcnt vmcnt(10)
    buffer_load_dwordx4 v231, s[12:15], s61 offen offset:3072 nt lds
    buffer_load_dwordx4 v[100:103], v233, s[24:27], s40 offen offset:1024
    s_mov_b32 m0, 73728
    s_add_u32 s61, s60, 139264
    s_and_b32 s61, s61, 0x3ffff
    s_or_b32 s61, s61, s3
    s_waitcnt vmcnt(10)
    buffer_load_dwordx4 v228, s[12:15], s61 offen offset:0 nt lds
    s_waitcnt vmcnt(10)
    buffer_load_dwordx4 v229, s[12:15], s61 offen offset:1024 nt lds
    s_waitcnt vmcnt(13)
    s_barrier
    s_waitcnt vmcnt(10)
    buffer_load_dwordx4 v230, s[12:15], s61 offen offset:2048 nt lds
    s_waitcnt vmcnt(10)
    buffer_load_dwordx4 v231, s[12:15], s61 offen offset:3072 nt lds
    buffer_load_dwordx4 v[104:107], v234, s[24:27], s40 offen offset:2048
    s_mov_b32 m0, 77824
    s_add_u32 s61, s60, 143360
    s_and_b32 s61, s61, 0x3ffff
    s_or_b32 s61, s61, s3
    s_waitcnt vmcnt(10)
    buffer_load_dwordx4 v228, s[12:15], s61 offen offset:0 nt lds
    s_waitcnt vmcnt(10)
    buffer_load_dwordx4 v229, s[12:15], s61 offen offset:1024 nt lds
    s_waitcnt vmcnt(10)
    buffer_load_dwordx4 v230, s[12:15], s61 offen offset:2048 nt lds
    s_waitcnt vmcnt(10)
    buffer_load_dwordx4 v231, s[12:15], s61 offen offset:3072 nt lds
    buffer_load_dwordx4 v[108:111], v235, s[24:27], s40 offen offset:3072
    s_mov_b32 m0, 0
    s_add_u32 s61, s60, 147456
    s_and_b32 s61, s61, 0x3ffff
    s_or_b32 s61, s61, s3
    s_waitcnt vmcnt(10)
    buffer_load_dwordx4 v228, s[12:15], s61 offen offset:0 nt lds
    s_waitcnt vmcnt(10)
    buffer_load_dwordx4 v229, s[12:15], s61 offen offset:1024 nt lds
    s_waitcnt vmcnt(10)
    buffer_load_dwordx4 v230, s[12:15], s61 offen offset:2048 nt lds
    s_waitcnt vmcnt(10)
    buffer_load_dwordx4 v231, s[12:15], s61 offen offset:3072 nt lds
    s_add_u32 s40, s50, 74496
    buffer_load_dwordx4 v[112:115], v232, s[24:27], s40 offen offset:0
    s_mov_b32 m0, 4096
    s_add_u32 s61, s60, 151552
    s_and_b32 s61, s61, 0x3ffff
    s_or_b32 s61, s61, s3
    s_waitcnt vmcnt(10)
    buffer_load_dwordx4 v228, s[12:15], s61 offen offset:0 nt lds
    s_waitcnt vmcnt(10)
    buffer_load_dwordx4 v229, s[12:15], s61 offen offset:1024 nt lds
    s_waitcnt vmcnt(10)
    buffer_load_dwordx4 v230, s[12:15], s61 offen offset:2048 nt lds
    s_waitcnt vmcnt(10)
    buffer_load_dwordx4 v231, s[12:15], s61 offen offset:3072 nt lds
    buffer_load_dwordx4 v[116:119], v233, s[24:27], s40 offen offset:1024
    s_mov_b32 m0, 8192
    s_add_u32 s61, s60, 155648
    s_and_b32 s61, s61, 0x3ffff
    s_or_b32 s61, s61, s3
    s_waitcnt vmcnt(10)
    buffer_load_dwordx4 v228, s[12:15], s61 offen offset:0 nt lds
    s_waitcnt vmcnt(12)
    s_barrier
    s_waitcnt vmcnt(10)
    buffer_load_dwordx4 v229, s[12:15], s61 offen offset:1024 nt lds
    s_waitcnt vmcnt(10)
    buffer_load_dwordx4 v230, s[12:15], s61 offen offset:2048 nt lds
    s_waitcnt vmcnt(10)
    buffer_load_dwordx4 v231, s[12:15], s61 offen offset:3072 nt lds
    buffer_load_dwordx4 v[120:123], v234, s[24:27], s40 offen offset:2048
    s_mov_b32 m0, 12288
    s_add_u32 s61, s60, 159744
    s_and_b32 s61, s61, 0x3ffff
    s_or_b32 s61, s61, s3
    s_waitcnt vmcnt(10)
    buffer_load_dwordx4 v228, s[12:15], s61 offen offset:0 nt lds
    s_waitcnt vmcnt(10)
    buffer_load_dwordx4 v229, s[12:15], s61 offen offset:1024 nt lds
    s_waitcnt vmcnt(10)
    buffer_load_dwordx4 v230, s[12:15], s61 offen offset:2048 nt lds
    s_waitcnt vmcnt(10)
    buffer_load_dwordx4 v231, s[12:15], s61 offen offset:3072 nt lds
    buffer_load_dwordx4 v[124:127], v235, s[24:27], s40 offen offset:3072
    s_mov_b32 m0, 32768
    s_add_u32 s61, s60, 163840
    s_and_b32 s61, s61, 0x3ffff
    s_or_b32 s61, s61, s3
    s_waitcnt vmcnt(10)
    buffer_load_dwordx4 v228, s[12:15], s61 offen offset:0 nt lds
    s_waitcnt vmcnt(10)
    buffer_load_dwordx4 v229, s[12:15], s61 offen offset:1024 nt lds
    s_waitcnt vmcnt(10)
    buffer_load_dwordx4 v230, s[12:15], s61 offen offset:2048 nt lds
    s_waitcnt vmcnt(10)
    buffer_load_dwordx4 v231, s[12:15], s61 offen offset:3072 nt lds
    s_add_u32 s40, s50, 111360
    buffer_load_dwordx4 v[128:131], v232, s[24:27], s40 offen offset:0
    s_mov_b32 m0, 36864
    s_add_u32 s61, s60, 167936
    s_and_b32 s61, s61, 0x3ffff
    s_or_b32 s61, s61, s3
    s_waitcnt vmcnt(10)
    buffer_load_dwordx4 v228, s[12:15], s61 offen offset:0 nt lds
    s_waitcnt vmcnt(10)
    buffer_load_dwordx4 v229, s[12:15], s61 offen offset:1024 nt lds
    s_waitcnt vmcnt(10)
    buffer_load_dwordx4 v230, s[12:15], s61 offen offset:2048 nt lds
    s_waitcnt vmcnt(10)
    buffer_load_dwordx4 v231, s[12:15], s61 offen offset:3072 nt lds
    buffer_load_dwordx4 v[132:135], v233, s[24:27], s40 offen offset:1024
    s_waitcnt vmcnt(11)
    s_barrier
    s_mov_b32 m0, 40960
    s_add_u32 s61, s60, 172032
    s_and_b32 s61, s61, 0x3ffff
    s_or_b32 s61, s61, s3
    s_waitcnt vmcnt(10)
    buffer_load_dwordx4 v228, s[12:15], s61 offen offset:0 nt lds
    s_waitcnt vmcnt(10)
    buffer_load_dwordx4 v229, s[12:15], s61 offen offset:1024 nt lds
    s_waitcnt vmcnt(10)
    buffer_load_dwordx4 v230, s[12:15], s61 offen offset:2048 nt lds
    s_waitcnt vmcnt(10)
    buffer_load_dwordx4 v231, s[12:15], s61 offen offset:3072 nt lds
    buffer_load_dwordx4 v[136:139], v234, s[24:27], s40 offen offset:2048
    s_mov_b32 m0, 45056
    s_add_u32 s61, s60, 176128
    s_and_b32 s61, s61, 0x3ffff
    s_or_b32 s61, s61, s3
    s_waitcnt vmcnt(10)
    buffer_load_dwordx4 v228, s[12:15], s61 offen offset:0 nt lds
    s_waitcnt vmcnt(10)
    buffer_load_dwordx4 v229, s[12:15], s61 offen offset:1024 nt lds
    s_waitcnt vmcnt(10)
    buffer_load_dwordx4 v230, s[12:15], s61 offen offset:2048 nt lds
    s_waitcnt vmcnt(10)
    buffer_load_dwordx4 v231, s[12:15], s61 offen offset:3072 nt lds
    buffer_load_dwordx4 v[140:143], v235, s[24:27], s40 offen offset:3072
    s_mov_b32 m0, 65536
    s_add_u32 s61, s60, 180224
    s_and_b32 s61, s61, 0x3ffff
    s_or_b32 s61, s61, s3
    s_waitcnt vmcnt(10)
    buffer_load_dwordx4 v228, s[12:15], s61 offen offset:0 nt lds
    s_waitcnt vmcnt(10)
    buffer_load_dwordx4 v229, s[12:15], s61 offen offset:1024 nt lds
    s_waitcnt vmcnt(10)
    buffer_load_dwordx4 v230, s[12:15], s61 offen offset:2048 nt lds
    s_waitcnt vmcnt(10)
    buffer_load_dwordx4 v231, s[12:15], s61 offen offset:3072 nt lds
    s_add_u32 s40, s50, 1024
    buffer_load_dwordx4 v[144:147], v232, s[24:27], s40 offen offset:0
    s_mov_b32 m0, 69632
    s_add_u32 s61, s60, 184320
    s_and_b32 s61, s61, 0x3ffff
    s_or_b32 s61, s61, s3
    s_waitcnt vmcnt(10)
    buffer_load_dwordx4 v228, s[12:15], s61 offen offset:0 nt lds
    s_waitcnt vmcnt(10)
    buffer_load_dwordx4 v229, s[12:15], s61 offen offset:1024 nt lds
    s_waitcnt vmcnt(10)
    buffer_load_dwordx4 v230, s[12:15], s61 offen offset:2048 nt lds
    s_waitcnt vmcnt(10)
    buffer_load_dwordx4 v231, s[12:15], s61 offen offset:3072 nt lds
    buffer_load_dwordx4 v[148:151], v233, s[24:27], s40 offen offset:1024
    s_waitcnt vmcnt(11)
    s_barrier
    s_mov_b32 m0, 73728
    s_add_u32 s61, s60, 188416
    s_and_b32 s61, s61, 0x3ffff
    s_or_b32 s61, s61, s3
    s_waitcnt vmcnt(10)
    buffer_load_dwordx4 v228, s[12:15], s61 offen offset:0 nt lds
    s_waitcnt vmcnt(10)
    buffer_load_dwordx4 v229, s[12:15], s61 offen offset:1024 nt lds
    s_waitcnt vmcnt(10)
    buffer_load_dwordx4 v230, s[12:15], s61 offen offset:2048 nt lds
    s_waitcnt vmcnt(10)
    buffer_load_dwordx4 v231, s[12:15], s61 offen offset:3072 nt lds
    buffer_load_dwordx4 v[152:155], v234, s[24:27], s40 offen offset:2048
    s_mov_b32 m0, 77824
    s_add_u32 s61, s60, 192512
    s_and_b32 s61, s61, 0x3ffff
    s_or_b32 s61, s61, s3
    s_waitcnt vmcnt(10)
    buffer_load_dwordx4 v228, s[12:15], s61 offen offset:0 nt lds
    s_waitcnt vmcnt(10)
    buffer_load_dwordx4 v229, s[12:15], s61 offen offset:1024 nt lds
    s_waitcnt vmcnt(10)
    buffer_load_dwordx4 v230, s[12:15], s61 offen offset:2048 nt lds
    s_waitcnt vmcnt(10)
    buffer_load_dwordx4 v231, s[12:15], s61 offen offset:3072 nt lds
    buffer_load_dwordx4 v[156:159], v235, s[24:27], s40 offen offset:3072
    s_mov_b32 m0, 0
    s_add_u32 s61, s60, 196608
    s_and_b32 s61, s61, 0x3ffff
    s_or_b32 s61, s61, s3
    s_waitcnt vmcnt(10)
    buffer_load_dwordx4 v228, s[12:15], s61 offen offset:0 nt lds
    s_waitcnt vmcnt(10)
    buffer_load_dwordx4 v229, s[12:15], s61 offen offset:1024 nt lds
    s_waitcnt vmcnt(10)
    buffer_load_dwordx4 v230, s[12:15], s61 offen offset:2048 nt lds
    s_waitcnt vmcnt(10)
    buffer_load_dwordx4 v231, s[12:15], s61 offen offset:3072 nt lds
    s_add_u32 s40, s50, 37888
    buffer_load_dwordx4 v[160:163], v232, s[24:27], s40 offen offset:0
    s_mov_b32 m0, 4096
    s_add_u32 s61, s60, 200704
    s_and_b32 s61, s61, 0x3ffff
    s_or_b32 s61, s61, s3
    s_waitcnt vmcnt(10)
    buffer_load_dwordx4 v228, s[12:15], s61 offen offset:0 nt lds
    s_waitcnt vmcnt(10)
    buffer_load_dwordx4 v229, s[12:15], s61 offen offset:1024 nt lds
    s_waitcnt vmcnt(10)
    buffer_load_dwordx4 v230, s[12:15], s61 offen offset:2048 nt lds
    s_waitcnt vmcnt(10)
    buffer_load_dwordx4 v231, s[12:15], s61 offen offset:3072 nt lds
    buffer_load_dwordx4 v[164:167], v233, s[24:27], s40 offen offset:1024
    buffer_load_dword v238, v227, s[24:27], s52 offen
    buffer_load_dwordx2 v[4:5], off, s[16:19], s51 sc1
    s_waitcnt vmcnt(13)
    s_barrier
    s_mov_b32 m0, 8192
    s_add_u32 s61, s60, 204800
    s_and_b32 s61, s61, 0x3ffff
    s_or_b32 s61, s61, s3
    s_waitcnt vmcnt(10)
    buffer_load_dwordx4 v228, s[12:15], s61 offen offset:0 nt lds
    s_waitcnt vmcnt(10)
    buffer_load_dwordx4 v229, s[12:15], s61 offen offset:1024 nt lds
    s_waitcnt vmcnt(10)
    buffer_load_dwordx4 v230, s[12:15], s61 offen offset:2048 nt lds
    s_waitcnt vmcnt(10)
    buffer_load_dwordx4 v231, s[12:15], s61 offen offset:3072 nt lds
    buffer_load_dwordx4 v[168:171], v234, s[24:27], s40 offen offset:2048
    s_mov_b32 m0, 12288
    s_add_u32 s61, s60, 208896
    s_and_b32 s61, s61, 0x3ffff
    s_or_b32 s61, s61, s3
    s_waitcnt vmcnt(10)
    buffer_load_dwordx4 v228, s[12:15], s61 offen offset:0 nt lds
    s_waitcnt vmcnt(10)
    buffer_load_dwordx4 v229, s[12:15], s61 offen offset:1024 nt lds
    s_waitcnt vmcnt(10)
    buffer_load_dwordx4 v230, s[12:15], s61 offen offset:2048 nt lds
    s_waitcnt vmcnt(10)
    buffer_load_dwordx4 v231, s[12:15], s61 offen offset:3072 nt lds
    buffer_load_dwordx4 v[172:175], v235, s[24:27], s40 offen offset:3072
    s_mov_b32 m0, 32768
    s_add_u32 s61, s60, 212992
    s_and_b32 s61, s61, 0x3ffff
    s_or_b32 s61, s61, s3
    s_waitcnt vmcnt(10)
    buffer_load_dwordx4 v228, s[12:15], s61 offen offset:0 nt lds
    s_waitcnt vmcnt(10)
    buffer_load_dwordx4 v229, s[12:15], s61 offen offset:1024 nt lds
    s_waitcnt vmcnt(10)
    buffer_load_dwordx4 v230, s[12:15], s61 offen offset:2048 nt lds
    s_waitcnt vmcnt(10)
    buffer_load_dwordx4 v231, s[12:15], s61 offen offset:3072 nt lds
    s_add_u32 s40, s50, 74752
    buffer_load_dwordx4 v[176:179], v232, s[24:27], s40 offen offset:0
    s_mov_b32 m0, 36864
    s_add_u32 s61, s60, 217088
    s_and_b32 s61, s61, 0x3ffff
    s_or_b32 s61, s61, s3
    s_waitcnt vmcnt(10)
    buffer_load_dwordx4 v228, s[12:15], s61 offen offset:0 nt lds
    s_waitcnt vmcnt(10)
    buffer_load_dwordx4 v229, s[12:15], s61 offen offset:1024 nt lds
    s_waitcnt vmcnt(10)
    buffer_load_dwordx4 v230, s[12:15], s61 offen offset:2048 nt lds
    s_waitcnt vmcnt(10)
    buffer_load_dwordx4 v231, s[12:15], s61 offen offset:3072 nt lds
    buffer_load_dwordx4 v[180:183], v233, s[24:27], s40 offen offset:1024
    s_waitcnt vmcnt(11)
    s_barrier
    s_mov_b32 m0, 40960
    s_add_u32 s61, s60, 221184
    s_and_b32 s61, s61, 0x3ffff
    s_or_b32 s61, s61, s3
    s_waitcnt vmcnt(10)
    buffer_load_dwordx4 v228, s[12:15], s61 offen offset:0 nt lds
    s_waitcnt vmcnt(10)
    buffer_load_dwordx4 v229, s[12:15], s61 offen offset:1024 nt lds
    s_waitcnt vmcnt(10)
    buffer_load_dwordx4 v230, s[12:15], s61 offen offset:2048 nt lds
    s_waitcnt vmcnt(10)
    buffer_load_dwordx4 v231, s[12:15], s61 offen offset:3072 nt lds
    buffer_load_dwordx4 v[184:187], v234, s[24:27], s40 offen offset:2048
    s_mov_b32 m0, 45056
    s_add_u32 s61, s60, 225280
    s_and_b32 s61, s61, 0x3ffff
    s_or_b32 s61, s61, s3
    s_waitcnt vmcnt(10)
    buffer_load_dwordx4 v228, s[12:15], s61 offen offset:0 nt lds
    s_waitcnt vmcnt(10)
    buffer_load_dwordx4 v229, s[12:15], s61 offen offset:1024 nt lds
    s_waitcnt vmcnt(10)
    buffer_load_dwordx4 v230, s[12:15], s61 offen offset:2048 nt lds
    s_waitcnt vmcnt(10)
    buffer_load_dwordx4 v231, s[12:15], s61 offen offset:3072 nt lds
    buffer_load_dwordx4 v[188:191], v235, s[24:27], s40 offen offset:3072
    s_mov_b32 m0, 65536
    s_add_u32 s61, s60, 229376
    s_and_b32 s61, s61, 0x3ffff
    s_or_b32 s61, s61, s3
    s_waitcnt vmcnt(10)
    buffer_load_dwordx4 v228, s[12:15], s61 offen offset:0 nt lds
    s_waitcnt vmcnt(10)
    buffer_load_dwordx4 v229, s[12:15], s61 offen offset:1024 nt lds
    s_waitcnt vmcnt(10)
    buffer_load_dwordx4 v230, s[12:15], s61 offen offset:2048 nt lds
    s_waitcnt vmcnt(10)
    buffer_load_dwordx4 v231, s[12:15], s61 offen offset:3072 nt lds
    s_add_u32 s40, s50, 111616
    buffer_load_dwordx4 v[192:195], v232, s[24:27], s40 offen offset:0
    s_mov_b32 m0, 69632
    s_add_u32 s61, s60, 233472
    s_and_b32 s61, s61, 0x3ffff
    s_or_b32 s61, s61, s3
    s_waitcnt vmcnt(10)
    buffer_load_dwordx4 v228, s[12:15], s61 offen offset:0 nt lds
    s_waitcnt vmcnt(10)
    buffer_load_dwordx4 v229, s[12:15], s61 offen offset:1024 nt lds
    s_waitcnt vmcnt(10)
    buffer_load_dwordx4 v230, s[12:15], s61 offen offset:2048 nt lds
    s_waitcnt vmcnt(10)
    buffer_load_dwordx4 v231, s[12:15], s61 offen offset:3072 nt lds
    buffer_load_dwordx4 v[196:199], v233, s[24:27], s40 offen offset:1024
    s_waitcnt vmcnt(11)
    s_barrier
    s_mov_b32 m0, 73728
    s_add_u32 s61, s60, 237568
    s_and_b32 s61, s61, 0x3ffff
    s_or_b32 s61, s61, s3
    s_waitcnt vmcnt(10)
    buffer_load_dwordx4 v228, s[12:15], s61 offen offset:0 nt lds
    s_waitcnt vmcnt(10)
    buffer_load_dwordx4 v229, s[12:15], s61 offen offset:1024 nt lds
    s_waitcnt vmcnt(10)
    buffer_load_dwordx4 v230, s[12:15], s61 offen offset:2048 nt lds
    s_waitcnt vmcnt(10)
    buffer_load_dwordx4 v231, s[12:15], s61 offen offset:3072 nt lds
    buffer_load_dwordx4 v[200:203], v234, s[24:27], s40 offen offset:2048
    s_mov_b32 m0, 77824
    s_add_u32 s61, s60, 241664
    s_and_b32 s61, s61, 0x3ffff
    s_or_b32 s61, s61, s3
    s_waitcnt vmcnt(10)
    buffer_load_dwordx4 v228, s[12:15], s61 offen offset:0 nt lds
    s_waitcnt vmcnt(10)
    buffer_load_dwordx4 v229, s[12:15], s61 offen offset:1024 nt lds
    s_waitcnt vmcnt(10)
    buffer_load_dwordx4 v230, s[12:15], s61 offen offset:2048 nt lds
    s_waitcnt vmcnt(10)
    buffer_load_dwordx4 v231, s[12:15], s61 offen offset:3072 nt lds
    buffer_load_dwordx4 v[204:207], v235, s[24:27], s40 offen offset:3072
    s_mov_b32 m0, 0
    s_add_u32 s61, s60, 245760
    s_and_b32 s61, s61, 0x3ffff
    s_or_b32 s61, s61, s3
    s_waitcnt vmcnt(8)
    buffer_load_dwordx4 v228, s[12:15], s61 offen offset:0 nt lds
    s_waitcnt vmcnt(8)
    buffer_load_dwordx4 v229, s[12:15], s61 offen offset:1024 nt lds
    s_waitcnt vmcnt(8)
    buffer_load_dwordx4 v230, s[12:15], s61 offen offset:2048 nt lds
    s_waitcnt vmcnt(8)
    buffer_load_dwordx4 v231, s[12:15], s61 offen offset:3072 nt lds
    s_mov_b32 m0, 4096
    s_add_u32 s61, s60, 249856
    s_and_b32 s61, s61, 0x3ffff
    s_or_b32 s61, s61, s3
    s_waitcnt vmcnt(8)
    buffer_load_dwordx4 v228, s[12:15], s61 offen offset:0 nt lds
    s_waitcnt vmcnt(8)
    buffer_load_dwordx4 v229, s[12:15], s61 offen offset:1024 nt lds
    s_waitcnt vmcnt(8)
    buffer_load_dwordx4 v230, s[12:15], s61 offen offset:2048 nt lds
    s_waitcnt vmcnt(8)
    buffer_load_dwordx4 v231, s[12:15], s61 offen offset:3072 nt lds
    s_waitcnt vmcnt(9)
    s_barrier
    s_mov_b32 m0, 8192
    s_add_u32 s61, s60, 253952
    s_and_b32 s61, s61, 0x3ffff
    s_or_b32 s61, s61, s3
    s_waitcnt vmcnt(8)
    buffer_load_dwordx4 v228, s[12:15], s61 offen offset:0 nt lds
    s_waitcnt vmcnt(8)
    buffer_load_dwordx4 v229, s[12:15], s61 offen offset:1024 nt lds
    s_waitcnt vmcnt(8)
    buffer_load_dwordx4 v230, s[12:15], s61 offen offset:2048 nt lds
    s_waitcnt vmcnt(8)
    buffer_load_dwordx4 v231, s[12:15], s61 offen offset:3072 nt lds
    s_mov_b32 m0, 12288
    s_add_u32 s61, s60, 258048
    s_and_b32 s61, s61, 0x3ffff
    s_or_b32 s61, s61, s3
    s_waitcnt vmcnt(8)
    buffer_load_dwordx4 v228, s[12:15], s61 offen offset:0 nt lds
    s_waitcnt vmcnt(8)
    buffer_load_dwordx4 v229, s[12:15], s61 offen offset:1024 nt lds
    s_waitcnt vmcnt(8)
    buffer_load_dwordx4 v230, s[12:15], s61 offen offset:2048 nt lds
    s_waitcnt vmcnt(8)
    buffer_load_dwordx4 v231, s[12:15], s61 offen offset:3072 nt lds
    s_waitcnt vmcnt(0)
    s_barrier
    s_branch L_kv_t
L_kv_v:
    s_add_u32 m0, s56, 98304
    s_add_u32 s56, s56, 16384
    buffer_load_dwordx4 v240, s[20:23], s55 offen offset:0 lds
    buffer_load_dwordx4 v241, s[20:23], s55 offen offset:1024 lds
    buffer_load_dwordx4 v242, s[20:23], s55 offen offset:2048 lds
    buffer_load_dwordx4 v243, s[20:23], s55 offen offset:3072 lds
    s_and_b32 s56, s56, 0xffff
    s_add_u32 s55, s55, 0x40000
    s_cmp_ge_u32 s55, s7
    s_cselect_b32 s42, s22, 0
    s_sub_u32 s55, s55, s42
    s_waitcnt vmcnt(18)
    s_barrier
    s_add_u32 m0, s56, 98304
    s_add_u32 s56, s56, 16384
    buffer_load_dwordx4 v240, s[20:23], s55 offen offset:0 lds
    buffer_load_dwordx4 v241, s[20:23], s55 offen offset:1024 lds
    buffer_load_dwordx4 v242, s[20:23], s55 offen offset:2048 lds
    buffer_load_dwordx4 v243, s[20:23], s55 offen offset:3072 lds
    s_and_b32 s56, s56, 0xffff
    s_add_u32 s55, s55, 0x40000
    s_cmp_ge_u32 s55, s7
    s_cselect_b32 s42, s22, 0
    s_sub_u32 s55, s55, s42
    s_waitcnt vmcnt(13)
    s_barrier
    s_add_u32 m0, s56, 98304
    s_add_u32 s56, s56, 16384
    buffer_load_dwordx4 v240, s[20:23], s55 offen offset:0 lds
    buffer_load_dwordx4 v241, s[20:23], s55 offen offset:1024 lds
    buffer_load_dwordx4 v242, s[20:23], s55 offen offset:2048 lds
    buffer_load_dwordx4 v243, s[20:23], s55 offen offset:3072 lds
    s_and_b32 s56, s56, 0xffff
    s_add_u32 s55, s55, 0x40000
    s_cmp_ge_u32 s55, s7
    s_cselect_b32 s42, s22, 0
    s_sub_u32 s55, s55, s42
    s_waitcnt vmcnt(8)
    s_barrier
    s_add_u32 m0, s56, 98304
    s_add_u32 s56, s56, 16384
    buffer_load_dwordx4 v240, s[20:23], s55 offen offset:0 lds
    buffer_load_dwordx4 v241, s[20:23], s55 offen offset:1024 lds
    buffer_load_dwordx4 v242, s[20:23], s55 offen offset:2048 lds
    buffer_load_dwordx4 v243, s[20:23], s55 offen offset:3072 lds
    s_and_b32 s56, s56, 0xffff
    s_add_u32 s55, s55, 0x40000
    s_cmp_ge_u32 s55, s7
    s_cselect_b32 s42, s22, 0
    s_sub_u32 s55, s55, s42
    s_waitcnt vmcnt(8)
    s_barrier
    s_add_u32 m0, s56, 98304
    s_add_u32 s56, s56, 16384
    buffer_load_dwordx4 v240, s[20:23], s55 offen offset:0 lds
    buffer_load_dwordx4 v241, s[20:23], s55 offen offset:1024 lds
    buffer_load_dwordx4 v242, s[20:23], s55 offen offset:2048 lds
    buffer_load_dwordx4 v243, s[20:23], s55 offen offset:3072 lds
    s_and_b32 s56, s56, 0xffff
    s_add_u32 s55, s55, 0x40000
    s_cmp_ge_u32 s55, s7
    s_cselect_b32 s42, s22, 0
    s_sub_u32 s55, s55, s42
    s_waitcnt vmcnt(8)
    s_barrier
    s_add_u32 m0, s56, 98304
    s_add_u32 s56, s56, 16384
    buffer_load_dwordx4 v240, s[20:23], s55 offen offset:0 lds
    buffer_load_dwordx4 v241, s[20:23], s55 offen offset:1024 lds
    buffer_load_dwordx4 v242, s[20:23], s55 offen offset:2048 lds
    buffer_load_dwordx4 v243, s[20:23], s55 offen offset:3072 lds
    s_and_b32 s56, s56, 0xffff
    s_add_u32 s55, s55, 0x40000
    s_cmp_ge_u32 s55, s7
    s_cselect_b32 s42, s22, 0
    s_sub_u32 s55, s55, s42
    s_waitcnt vmcnt(8)
    s_barrier
    s_add_u32 m0, s56, 98304
    s_add_u32 s56, s56, 16384
    buffer_load_dwordx4 v240, s[20:23], s55 offen offset:0 lds
    buffer_load_dwordx4 v241, s[20:23], s55 offen offset:1024 lds
    buffer_load_dwordx4 v242, s[20:23], s55 offen offset:2048 lds
    buffer_load_dwordx4 v243, s[20:23], s55 offen offset:3072 lds
    s_and_b32 s56, s56, 0xffff
    s_add_u32 s55, s55, 0x40000
    s_cmp_ge_u32 s55, s7
    s_cselect_b32 s42, s22, 0
    s_sub_u32 s55, s55, s42
    s_waitcnt vmcnt(8)
    s_barrier
    s_add_u32 m0, s56, 98304
    s_add_u32 s56, s56, 16384
    buffer_load_dwordx4 v240, s[20:23], s55 offen offset:0 lds
    buffer_load_dwordx4 v241, s[20:23], s55 offen offset:1024 lds
    buffer_load_dwordx4 v242, s[20:23], s55 offen offset:2048 lds
    buffer_load_dwordx4 v243, s[20:23], s55 offen offset:3072 lds
    s_and_b32 s56, s56, 0xffff
    s_add_u32 s55, s55, 0x40000
    s_cmp_ge_u32 s55, s7
    s_cselect_b32 s42, s22, 0
    s_sub_u32 s55, s55, s42
    s_waitcnt vmcnt(8)
    s_barrier
    s_add_u32 m0, s56, 98304
    s_add_u32 s56, s56, 16384
    buffer_load_dwordx4 v240, s[20:23], s55 offen offset:0 lds
    buffer_load_dwordx4 v241, s[20:23], s55 offen offset:1024 lds
    buffer_load_dwordx4 v242, s[20:23], s55 offen offset:2048 lds
    buffer_load_dwordx4 v243, s[20:23], s55 offen offset:3072 lds
    s_and_b32 s56, s56, 0xffff
    s_add_u32 s55, s55, 0x40000
    s_cmp_ge_u32 s55, s7
    s_cselect_b32 s42, s22, 0
    s_sub_u32 s55, s55, s42
    s_mov_b32 m0, 49152
    s_add_u32 s61, s60, 0
    s_and_b32 s61, s61, 0x3ffff
    s_or_b32 s61, s61, s3
    buffer_load_dwordx4 v228, s[12:15], s61 offen offset:0 nt lds
    buffer_load_dwordx4 v229, s[12:15], s61 offen offset:1024 nt lds
    buffer_load_dwordx4 v230, s[12:15], s61 offen offset:2048 nt lds
    buffer_load_dwordx4 v231, s[12:15], s61 offen offset:3072 nt lds
    s_waitcnt vmcnt(12)
    s_barrier
    s_mov_b32 m0, 53248
    s_add_u32 s61, s60, 4096
    s_and_b32 s61, s61, 0x3ffff
    s_or_b32 s61, s61, s3
    buffer_load_dwordx4 v228, s[12:15], s61 offen offset:0 nt lds
    buffer_load_dwordx4 v229, s[12:15], s61 offen offset:1024 nt lds
    buffer_load_dwordx4 v230, s[12:15], s61 offen offset:2048 nt lds
    buffer_load_dwordx4 v231, s[12:15], s61 offen offset:3072 nt lds
    s_waitcnt vmcnt(12)
    s_barrier
    s_mov_b32 m0, 57344
    s_add_u32 s61, s60, 8192
    s_and_b32 s61, s61, 0x3ffff
    s_or_b32 s61, s61, s3
    buffer_load_dwordx4 v228, s[12:15], s61 offen offset:0 nt lds
    buffer_load_dwordx4 v229, s[12:15], s61 offen offset:1024 nt lds
    buffer_load_dwordx4 v230, s[12:15], s61 offen offset:2048 nt lds
    buffer_load_dwordx4 v231, s[12:15], s61 offen offset:3072 nt lds
    s_waitcnt vmcnt(12)
    s_barrier
    s_mov_b32 m0, 61440
    s_add_u32 s61, s60, 12288
    s_and_b32 s61, s61, 0x3ffff
    s_or_b32 s61, s61, s3
    buffer_load_dwordx4 v228, s[12:15], s61 offen offset:0 nt lds
    buffer_load_dwordx4 v229, s[12:15], s61 offen offset:1024 nt lds
    buffer_load_dwordx4 v230, s[12:15], s61 offen offset:2048 nt lds
    buffer_load_dwordx4 v231, s[12:15], s61 offen offset:3072 nt lds
    s_barrier
    s_mov_b32 m0, 81920
    s_add_u32 s61, s60, 16384
    s_and_b32 s61, s61, 0x3ffff
    s_or_b32 s61, s61, s3
    buffer_load_dwordx4 v228, s[12:15], s61 offen offset:0 nt lds
    buffer_load_dwordx4 v229, s[12:15], s61 offen offset:1024 nt lds
    buffer_load_dwordx4 v230, s[12:15], s61 offen offset:2048 nt lds
    buffer_load_dwordx4 v231, s[12:15], s61 offen offset:3072 nt lds
    s_mov_b32 m0, 86016
    s_add_u32 s61, s60, 20480
    s_and_b32 s61, s61, 0x3ffff
    s_or_b32 s61, s61, s3
    buffer_load_dwordx4 v228, s[12:15], s61 offen offset:0 nt lds
    buffer_load_dwordx4 v229, s[12:15], s61 offen offset:1024 nt lds
    buffer_load_dwordx4 v230, s[12:15], s61 offen offset:2048 nt lds
    buffer_load_dwordx4 v231, s[12:15], s61 offen offset:3072 nt lds
    s_barrier
    s_mov_b32 m0, 90112
    s_add_u32 s61, s60, 24576
    s_and_b32 s61, s61, 0x3ffff
    s_or_b32 s61, s61, s3
    buffer_load_dwordx4 v228, s[12:15], s61 offen offset:0 nt lds
    buffer_load_dwordx4 v229, s[12:15], s61 offen offset:1024 nt lds
    buffer_load_dwordx4 v230, s[12:15], s61 offen offset:2048 nt lds
    buffer_load_dwordx4 v231, s[12:15], s61 offen offset:3072 nt lds
    s_mov_b32 m0, 94208
    s_add_u32 s61, s60, 28672
    s_and_b32 s61, s61, 0x3ffff
    s_or_b32 s61, s61, s3
    buffer_load_dwordx4 v228, s[12:15], s61 offen offset:0 nt lds
    buffer_load_dwordx4 v229, s[12:15], s61 offen offset:1024 nt lds
    buffer_load_dwordx4 v230, s[12:15], s61 offen offset:2048 nt lds
    buffer_load_dwordx4 v231, s[12:15], s61 offen offset:3072 nt lds
    s_barrier
    s_waitcnt vmcnt(16)
    s_barrier
    s_mov_b32 m0, 16384
    s_add_u32 s61, s60, 32768
    s_and_b32 s61, s61, 0x3ffff
    s_or_b32 s61, s61, s3
    s_waitcnt vmcnt(10)
    buffer_load_dwordx4 v228, s[12:15], s61 offen offset:0 nt lds
    s_waitcnt vmcnt(10)
    buffer_load_dwordx4 v229, s[12:15], s61 offen offset:1024 nt lds
    s_waitcnt vmcnt(10)
    buffer_load_dwordx4 v230, s[12:15], s61 offen offset:2048 nt lds
    s_waitcnt vmcnt(10)
    buffer_load_dwordx4 v231, s[12:15], s61 offen offset:3072 nt lds
    s_add_u32 s40, s50, 512
    buffer_load_dwordx4 v[16:19], v232, s[24:27], s40 offen offset:0
    s_mov_b32 m0, 20480
    s_add_u32 s61, s60, 36864
    s_and_b32 s61, s61, 0x3ffff
    s_or_b32 s61, s61, s3
    s_waitcnt vmcnt(10)
    buffer_load_dwordx4 v228, s[12:15], s61 offen offset:0 nt lds
    s_waitcnt vmcnt(10)
    buffer_load_dwordx4 v229, s[12:15], s61 offen offset:1024 nt lds
    s_waitcnt vmcnt(10)
    buffer_load_dwordx4 v230, s[12:15], s61 offen offset:2048 nt lds
    s_waitcnt vmcnt(10)
    buffer_load_dwordx4 v231, s[12:15], s61 offen offset:3072 nt lds
    buffer_load_dwordx4 v[20:23], v233, s[24:27], s40 offen offset:1024
    s_mov_b32 m0, 24576
    s_add_u32 s61, s60, 40960
    s_and_b32 s61, s61, 0x3ffff
    s_or_b32 s61, s61, s3
    s_waitcnt vmcnt(10)
    buffer_load_dwordx4 v228, s[12:15], s61 offen offset:0 nt lds
    s_waitcnt vmcnt(10)
    buffer_load_dwordx4 v229, s[12:15], s61 offen offset:1024 nt lds
    s_waitcnt vmcnt(10)
    buffer_load_dwordx4 v230, s[12:15], s61 offen offset:2048 nt lds
    s_waitcnt vmcnt(10)
    buffer_load_dwordx4 v231, s[12:15], s61 offen offset:3072 nt lds
    buffer_load_dwordx4 v[24:27], v234, s[24:27], s40 offen offset:2048
    s_mov_b32 m0, 28672
    s_add_u32 s61, s60, 45056
    s_and_b32 s61, s61, 0x3ffff
    s_or_b32 s61, s61, s3
    s_waitcnt vmcnt(10)
    buffer_load_dwordx4 v228, s[12:15], s61 offen offset:0 nt lds
    s_waitcnt vmcnt(10)
    buffer_load_dwordx4 v229, s[12:15], s61 offen offset:1024 nt lds
    s_waitcnt vmcnt(10)
    buffer_load_dwordx4 v230, s[12:15], s61 offen offset:2048 nt lds
    s_waitcnt vmcnt(18)
    s_barrier
    s_waitcnt vmcnt(10)
    buffer_load_dwordx4 v231, s[12:15], s61 offen offset:3072 nt lds
    buffer_load_dwordx4 v[28:31], v235, s[24:27], s40 offen offset:3072
    s_mov_b32 m0, 49152
    s_add_u32 s61, s60, 49152
    s_and_b32 s61, s61, 0x3ffff
    s_or_b32 s61, s61, s3
    s_waitcnt vmcnt(10)
    buffer_load_dwordx4 v228, s[12:15], s61 offen offset:0 nt lds
    s_waitcnt vmcnt(10)
    buffer_load_dwordx4 v229, s[12:15], s61 offen offset:1024 nt lds
    s_waitcnt vmcnt(10)
    buffer_load_dwordx4 v230, s[12:15], s61 offen offset:2048 nt lds
    s_waitcnt vmcnt(10)
    buffer_load_dwordx4 v231, s[12:15], s61 offen offset:3072 nt lds
    s_add_u32 s40, s50, 37376
    buffer_load_dwordx4 v[32:35], v232, s[24:27], s40 offen offset:0
    s_mov_b32 m0, 53248
    s_add_u32 s61, s60, 53248
    s_and_b32 s61, s61, 0x3ffff
    s_or_b32 s61, s61, s3
    s_waitcnt vmcnt(10)
    buffer_load_dwordx4 v228, s[12:15], s61 offen offset:0 nt lds
    s_waitcnt vmcnt(10)
    buffer_load_dwordx4 v229, s[12:15], s61 offen offset:1024 nt lds
    s_waitcnt vmcnt(10)
    buffer_load_dwordx4 v230, s[12:15], s61 offen offset:2048 nt lds
    s_waitcnt vmcnt(10)
    buffer_load_dwordx4 v231, s[12:15], s61 offen offset:3072 nt lds
    buffer_load_dwordx4 v[36:39], v233, s[24:27], s40 offen offset:1024
    s_mov_b32 m0, 57344
    s_add_u32 s61, s60, 57344
    s_and_b32 s61, s61, 0x3ffff
    s_or_b32 s61, s61, s3
    s_waitcnt vmcnt(10)
    buffer_load_dwordx4 v228, s[12:15], s61 offen offset:0 nt lds
    s_waitcnt vmcnt(10)
    buffer_load_dwordx4 v229, s[12:15], s61 offen offset:1024 nt lds
    s_waitcnt vmcnt(10)
    buffer_load_dwordx4 v230, s[12:15], s61 offen offset:2048 nt lds
    s_waitcnt vmcnt(10)
    buffer_load_dwordx4 v231, s[12:15], s61 offen offset:3072 nt lds
    buffer_load_dwordx4 v[40:43], v234, s[24:27], s40 offen offset:2048
    s_mov_b32 m0, 61440
    s_add_u32 s61, s60, 61440
    s_and_b32 s61, s61, 0x3ffff
    s_or_b32 s61, s61, s3
    s_waitcnt vmcnt(10)
    buffer_load_dwordx4 v228, s[12:15], s61 offen offset:0 nt lds
    s_waitcnt vmcnt(10)
    buffer_load_dwordx4 v229, s[12:15], s61 offen offset:1024 nt lds
    s_waitcnt vmcnt(18)
    s_barrier
    s_waitcnt vmcnt(10)
    buffer_load_dwordx4 v230, s[12:15], s61 offen offset:2048 nt lds
    s_waitcnt vmcnt(10)
    buffer_load_dwordx4 v231, s[12:15], s61 offen offset:3072 nt lds
    buffer_load_dwordx4 v[44:47], v235, s[24:27], s40 offen offset:3072
    s_mov_b32 m0, 81920
    s_add_u32 s61, s60, 65536
    s_and_b32 s61, s61, 0x3ffff
    s_or_b32 s61, s61, s3
    s_waitcnt vmcnt(10)
    buffer_load_dwordx4 v228, s[12:15], s61 offen offset:0 nt lds
    s_waitcnt vmcnt(10)
    buffer_load_dwordx4 v229, s[12:15], s61 offen offset:1024 nt lds
    s_waitcnt vmcnt(10)
    buffer_load_dwordx4 v230, s[12:15], s61 offen offset:2048 nt lds
    s_waitcnt vmcnt(10)
    buffer_load_dwordx4 v231, s[12:15], s61 offen offset:3072 nt lds
    s_add_u32 s40, s50, 74240
    buffer_load_dwordx4 v[48:51], v232, s[24:27], s40 offen offset:0
    s_mov_b32 m0, 86016
    s_add_u32 s61, s60, 69632
    s_and_b32 s61, s61, 0x3ffff
    s_or_b32 s61, s61, s3
    s_waitcnt vmcnt(10)
    buffer_load_dwordx4 v228, s[12:15], s61 offen offset:0 nt lds
    s_waitcnt vmcnt(10)
    buffer_load_dwordx4 v229, s[12:15], s61 offen offset:1024 nt lds
    s_waitcnt vmcnt(10)
    buffer_load_dwordx4 v230, s[12:15], s61 offen offset:2048 nt lds
    s_waitcnt vmcnt(10)
    buffer_load_dwordx4 v231, s[12:15], s61 offen offset:3072 nt lds
    buffer_load_dwordx4 v[52:55], v233, s[24:27], s40 offen offset:1024
    s_mov_b32 m0, 90112
    s_add_u32 s61, s60, 73728
    s_and_b32 s61, s61, 0x3ffff
    s_or_b32 s61, s61, s3
    s_waitcnt vmcnt(10)
    buffer_load_dwordx4 v228, s[12:15], s61 offen offset:0 nt lds
    s_waitcnt vmcnt(10)
    buffer_load_dwordx4 v229, s[12:15], s61 offen offset:1024 nt lds
    s_waitcnt vmcnt(10)
    buffer_load_dwordx4 v230, s[12:15], s61 offen offset:2048 nt lds
    s_waitcnt vmcnt(10)
    buffer_load_dwordx4 v231, s[12:15], s61 offen offset:3072 nt lds
    buffer_load_dwordx4 v[56:59], v234, s[24:27], s40 offen offset:2048
    s_mov_b32 m0, 94208
    s_add_u32 s61, s60, 77824
    s_and_b32 s61, s61, 0x3ffff
    s_or_b32 s61, s61, s3
    s_waitcnt vmcnt(10)
    buffer_load_dwordx4 v228, s[12:15], s61 offen offset:0 nt lds
    s_waitcnt vmcnt(17)
    s_barrier
    s_waitcnt vmcnt(10)
    buffer_load_dwordx4 v229, s[12:15], s61 offen offset:1024 nt lds
    s_waitcnt vmcnt(10)
    buffer_load_dwordx4 v230, s[12:15], s61 offen offset:2048 nt lds
    s_waitcnt vmcnt(10)
    buffer_load_dwordx4 v231, s[12:15], s61 offen offset:3072 nt lds
    buffer_load_dwordx4 v[60:63], v235, s[24:27], s40 offen offset:3072
    s_mov_b32 m0, 16384
    s_add_u32 s61, s60, 81920
    s_and_b32 s61, s61, 0x3ffff
    s_or_b32 s61, s61, s3
    s_waitcnt vmcnt(10)
    buffer_load_dwordx4 v228, s[12:15], s61 offen offset:0 nt lds
    s_waitcnt vmcnt(10)
    buffer_load_dwordx4 v229, s[12:15], s61 offen offset:1024 nt lds
    s_waitcnt vmcnt(10)
    buffer_load_dwordx4 v230, s[12:15], s61 offen offset:2048 nt lds
    s_waitcnt vmcnt(10)
    buffer_load_dwordx4 v231, s[12:15], s61 offen offset:3072 nt lds
    s_add_u32 s40, s50, 111104
    buffer_load_dwordx4 v[64:67], v232, s[24:27], s40 offen offset:0
    s_mov_b32 m0, 20480
    s_add_u32 s61, s60, 86016
    s_and_b32 s61, s61, 0x3ffff
    s_or_b32 s61, s61, s3
    s_waitcnt vmcnt(10)
    buffer_load_dwordx4 v228, s[12:15], s61 offen offset:0 nt lds
    s_waitcnt vmcnt(10)
    buffer_load_dwordx4 v229, s[12:15], s61 offen offset:1024 nt lds
    s_waitcnt vmcnt(10)
    buffer_load_dwordx4 v230, s[12:15], s61 offen offset:2048 nt lds
    s_waitcnt vmcnt(10)
    buffer_load_dwordx4 v231, s[12:15], s61 offen offset:3072 nt lds
    buffer_load_dwordx4 v[68:71], v233, s[24:27], s40 offen offset:1024
    s_mov_b32 m0, 24576
    s_add_u32 s61, s60, 90112
    s_and_b32 s61, s61, 0x3ffff
    s_or_b32 s61, s61, s3
    s_waitcnt vmcnt(10)
    buffer_load_dwordx4 v228, s[12:15], s61 offen offset:0 nt lds
    s_waitcnt vmcnt(10)
    buffer_load_dwordx4 v229, s[12:15], s61 offen offset:1024 nt lds
    s_waitcnt vmcnt(10)
    buffer_load_dwordx4 v230, s[12:15], s61 offen offset:2048 nt lds
    s_waitcnt vmcnt(10)
    buffer_load_dwordx4 v231, s[12:15], s61 offen offset:3072 nt lds
    buffer_load_dwordx4 v[72:75], v234, s[24:27], s40 offen offset:2048
    s_waitcnt vmcnt(16)
    s_barrier
    s_mov_b32 m0, 28672
    s_add_u32 s61, s60, 94208
    s_and_b32 s61, s61, 0x3ffff
    s_or_b32 s61, s61, s3
    s_waitcnt vmcnt(10)
    buffer_load_dwordx4 v228, s[12:15], s61 offen offset:0 nt lds
    s_waitcnt vmcnt(10)
    buffer_load_dwordx4 v229, s[12:15], s61 offen offset:1024 nt lds
    s_waitcnt vmcnt(10)
    buffer_load_dwordx4 v230, s[12:15], s61 offen offset:2048 nt lds
    s_waitcnt vmcnt(10)
    buffer_load_dwordx4 v231, s[12:15], s61 offen offset:3072 nt lds
    buffer_load_dwordx4 v[76:79], v235, s[24:27], s40 offen offset:3072
    s_mov_b32 m0, 49152
    s_add_u32 s61, s60, 98304
    s_and_b32 s61, s61, 0x3ffff
    s_or_b32 s61, s61, s3
    s_waitcnt vmcnt(10)
    buffer_load_dwordx4 v228, s[12:15], s61 offen offset:0 nt lds
    s_waitcnt vmcnt(10)
    buffer_load_dwordx4 v229, s[12:15], s61 offen offset:1024 nt lds
    s_waitcnt vmcnt(10)
    buffer_load_dwordx4 v230, s[12:15], s61 offen offset:2048 nt lds
    s_waitcnt vmcnt(10)
    buffer_load_dwordx4 v231, s[12:15], s61 offen offset:3072 nt lds
    s_add_u32 s40, s50, 768
    buffer_load_dwordx4 v[80:83], v232, s[24:27], s40 offen offset:0
    s_mov_b32 m0, 53248
    s_add_u32 s61, s60, 102400
    s_and_b32 s61, s61, 0x3ffff
    s_or_b32 s61, s61, s3
    s_waitcnt vmcnt(10)
    buffer_load_dwordx4 v228, s[12:15], s61 offen offset:0 nt lds
    s_waitcnt vmcnt(10)
    buffer_load_dwordx4 v229, s[12:15], s61 offen offset:1024 nt lds
    s_waitcnt vmcnt(10)
    buffer_load_dwordx4 v230, s[12:15], s61 offen offset:2048 nt lds
    s_waitcnt vmcnt(10)
    buffer_load_dwordx4 v231, s[12:15], s61 offen offset:3072 nt lds
    buffer_load_dwordx4 v[84:87], v233, s[24:27], s40 offen offset:1024
    s_mov_b32 m0, 57344
    s_add_u32 s61, s60, 106496
    s_and_b32 s61, s61, 0x3ffff
    s_or_b32 s61, s61, s3
    s_waitcnt vmcnt(10)
    buffer_load_dwordx4 v228, s[12:15], s61 offen offset:0 nt lds
    s_waitcnt vmcnt(10)
    buffer_load_dwordx4 v229, s[12:15], s61 offen offset:1024 nt lds
    s_waitcnt vmcnt(10)
    buffer_load_dwordx4 v230, s[12:15], s61 offen offset:2048 nt lds
    s_waitcnt vmcnt(14)
    s_barrier
    s_waitcnt vmcnt(10)
    buffer_load_dwordx4 v231, s[12:15], s61 offen offset:3072 nt lds
    buffer_load_dwordx4 v[88:91], v234, s[24:27], s40 offen offset:2048
    s_mov_b32 m0, 61440
    s_add_u32 s61, s60, 110592
    s_and_b32 s61, s61, 0x3ffff
    s_or_b32 s61, s61, s3
    s_waitcnt vmcnt(10)
    buffer_load_dwordx4 v228, s[12:15], s61 offen offset:0 nt lds
    s_waitcnt vmcnt(10)
    buffer_load_dwordx4 v229, s[12:15], s61 offen offset:1024 nt lds
    s_waitcnt vmcnt(10)
    buffer_load_dwordx4 v230, s[12:15], s61 offen offset:2048 nt lds
    s_waitcnt vmcnt(10)
    buffer_load_dwordx4 v231, s[12:15], s61 offen offset:3072 nt lds
    buffer_load_dwordx4 v[92:95], v235, s[24:27], s40 offen offset:3072
    s_mov_b32 m0, 81920
    s_add_u32 s61, s60, 114688
    s_and_b32 s61, s61, 0x3ffff
    s_or_b32 s61, s61, s3
    s_waitcnt vmcnt(10)
    buffer_load_dwordx4 v228, s[12:15], s61 offen offset:0 nt lds
    s_waitcnt vmcnt(10)
    buffer_load_dwordx4 v229, s[12:15], s61 offen offset:1024 nt lds
    s_waitcnt vmcnt(10)
    buffer_load_dwordx4 v230, s[12:15], s61 offen offset:2048 nt lds
    s_waitcnt vmcnt(10)
    buffer_load_dwordx4 v231, s[12:15], s61 offen offset:3072 nt lds
    s_add_u32 s40, s50, 37632
    buffer_load_dwordx4 v[96:99], v232, s[24:27], s40 offen offset:0
    s_mov_b32 m0, 86016
    s_add_u32 s61, s60, 118784
    s_and_b32 s61, s61, 0x3ffff
    s_or_b32 s61, s61, s3
    s_waitcnt vmcnt(10)
    buffer_load_dwordx4 v228, s[12:15], s61 offen offset:0 nt lds
    s_waitcnt vmcnt(10)
    buffer_load_dwordx4 v229, s[12:15], s61 offen offset:1024 nt lds
    s_waitcnt vmcnt(10)
    buffer_load_dwordx4 v230, s[12:15], s61 offen offset:2048 nt lds
    s_waitcnt vmcnt(10)
    buffer_load_dwordx4 v231, s[12:15], s61 offen offset:3072 nt lds
    buffer_load_dwordx4 v[100:103], v233, s[24:27], s40 offen offset:1024
    s_mov_b32 m0, 90112
    s_add_u32 s61, s60, 122880
    s_and_b32 s61, s61, 0x3ffff
    s_or_b32 s61, s61, s3
    s_waitcnt vmcnt(10)
    buffer_load_dwordx4 v228, s[12:15], s61 offen offset:0 nt lds
    s_waitcnt vmcnt(10)
    buffer_load_dwordx4 v229, s[12:15], s61 offen offset:1024 nt lds
    s_waitcnt vmcnt(13)
    s_barrier
    s_waitcnt vmcnt(10)
    buffer_load_dwordx4 v230, s[12:15], s61 offen offset:2048 nt lds
    s_waitcnt vmcnt(10)
    buffer_load_dwordx4 v231, s[12:15], s61 offen offset:3072 nt lds
    buffer_load_dwordx4 v[104:107], v234, s[24:27], s40 offen offset:2048
    s_mov_b32 m0, 94208
    s_add_u32 s61, s60, 126976
    s_and_b32 s61, s61, 0x3ffff
    s_or_b32 s61, s61, s3
    s_waitcnt vmcnt(10)
    buffer_load_dwordx4 v228, s[12:15], s61 offen offset:0 nt lds
    s_waitcnt vmcnt(10)
    buffer_load_dwordx4 v229, s[12:15], s61 offen offset:1024 nt lds
    s_waitcnt vmcnt(10)
    buffer_load_dwordx4 v230, s[12:15], s61 offen offset:2048 nt lds
    s_waitcnt vmcnt(10)
    buffer_load_dwordx4 v231, s[12:15], s61 offen offset:3072 nt lds
    buffer_load_dwordx4 v[108:111], v235, s[24:27], s40 offen offset:3072
    s_mov_b32 m0, 16384
    s_add_u32 s61, s60, 131072
    s_and_b32 s61, s61, 0x3ffff
    s_or_b32 s61, s61, s3
    s_waitcnt vmcnt(10)
    buffer_load_dwordx4 v228, s[12:15], s61 offen offset:0 nt lds
    s_waitcnt vmcnt(10)
    buffer_load_dwordx4 v229, s[12:15], s61 offen offset:1024 nt lds
    s_waitcnt vmcnt(10)
    buffer_load_dwordx4 v230, s[12:15], s61 offen offset:2048 nt lds
    s_waitcnt vmcnt(10)
    buffer_load_dwordx4 v231, s[12:15], s61 offen offset:3072 nt lds
    s_add_u32 s40, s50, 74496
    buffer_load_dwordx4 v[112:115], v232, s[24:27], s40 offen offset:0
    s_mov_b32 m0, 20480
    s_add_u32 s61, s60, 135168
    s_and_b32 s61, s61, 0x3ffff
    s_or_b32 s61, s61, s3
    s_waitcnt vmcnt(10)
    buffer_load_dwordx4 v228, s[12:15], s61 offen offset:0 nt lds
    s_waitcnt vmcnt(10)
    buffer_load_dwordx4 v229, s[12:15], s61 offen offset:1024 nt lds
    s_waitcnt vmcnt(10)
    buffer_load_dwordx4 v230, s[12:15], s61 offen offset:2048 nt lds
    s_waitcnt vmcnt(10)
    buffer_load_dwordx4 v231, s[12:15], s61 offen offset:3072 nt lds
    buffer_load_dwordx4 v[116:119], v233, s[24:27], s40 offen offset:1024
    s_mov_b32 m0, 24576
    s_add_u32 s61, s60, 139264
    s_and_b32 s61, s61, 0x3ffff
    s_or_b32 s61, s61, s3
    s_waitcnt vmcnt(10)
    buffer_load_dwordx4 v228, s[12:15], s61 offen offset:0 nt lds
    s_waitcnt vmcnt(12)
    s_barrier
    s_waitcnt vmcnt(10)
    buffer_load_dwordx4 v229, s[12:15], s61 offen offset:1024 nt lds
    s_waitcnt vmcnt(10)
    buffer_load_dwordx4 v230, s[12:15], s61 offen offset:2048 nt lds
    s_waitcnt vmcnt(10)
    buffer_load_dwordx4 v231, s[12:15], s61 offen offset:3072 nt lds
    buffer_load_dwordx4 v[120:123], v234, s[24:27], s40 offen offset:2048
    s_mov_b32 m0, 28672
    s_add_u32 s61, s60, 143360
    s_and_b32 s61, s61, 0x3ffff
    s_or_b32 s61, s61, s3
    s_waitcnt vmcnt(10)
    buffer_load_dwordx4 v228, s[12:15], s61 offen offset:0 nt lds
    s_waitcnt vmcnt(10)
    buffer_load_dwordx4 v229, s[12:15], s61 offen offset:1024 nt lds
    s_waitcnt vmcnt(10)
    buffer_load_dwordx4 v230, s[12:15], s61 offen offset:2048 nt lds
    s_waitcnt vmcnt(10)
    buffer_load_dwordx4 v231, s[12:15], s61 offen offset:3072 nt lds
    buffer_load_dwordx4 v[124:127], v235, s[24:27], s40 offen offset:3072
    s_mov_b32 m0, 49152
    s_add_u32 s61, s60, 147456
    s_and_b32 s61, s61, 0x3ffff
    s_or_b32 s61, s61, s3
    s_waitcnt vmcnt(10)
    buffer_load_dwordx4 v228, s[12:15], s61 offen offset:0 nt lds
    s_waitcnt vmcnt(10)
    buffer_load_dwordx4 v229, s[12:15], s61 offen offset:1024 nt lds
    s_waitcnt vmcnt(10)
    buffer_load_dwordx4 v230, s[12:15], s61 offen offset:2048 nt lds
    s_waitcnt vmcnt(10)
    buffer_load_dwordx4 v231, s[12:15], s61 offen offset:3072 nt lds
    s_add_u32 s40, s50, 111360
    buffer_load_dwordx4 v[128:131], v232, s[24:27], s40 offen offset:0
    s_mov_b32 m0, 53248
    s_add_u32 s61, s60, 151552
    s_and_b32 s61, s61, 0x3ffff
    s_or_b32 s61, s61, s3
    s_waitcnt vmcnt(10)
    buffer_load_dwordx4 v228, s[12:15], s61 offen offset:0 nt lds
    s_waitcnt vmcnt(10)
    buffer_load_dwordx4 v229, s[12:15], s61 offen offset:1024 nt lds
    s_waitcnt vmcnt(10)
    buffer_load_dwordx4 v230, s[12:15], s61 offen offset:2048 nt lds
    s_waitcnt vmcnt(10)
    buffer_load_dwordx4 v231, s[12:15], s61 offen offset:3072 nt lds
    buffer_load_dwordx4 v[132:135], v233, s[24:27], s40 offen offset:1024
    s_waitcnt vmcnt(11)
    s_barrier
    s_mov_b32 m0, 57344
    s_add_u32 s61, s60, 155648
    s_and_b32 s61, s61, 0x3ffff
    s_or_b32 s61, s61, s3
    s_waitcnt vmcnt(10)
    buffer_load_dwordx4 v228, s[12:15], s61 offen offset:0 nt lds
    s_waitcnt vmcnt(10)
    buffer_load_dwordx4 v229, s[12:15], s61 offen offset:1024 nt lds
    s_waitcnt vmcnt(10)
    buffer_load_dwordx4 v230, s[12:15], s61 offen offset:2048 nt lds
    s_waitcnt vmcnt(10)
    buffer_load_dwordx4 v231, s[12:15], s61 offen offset:3072 nt lds
    buffer_load_dwordx4 v[136:139], v234, s[24:27], s40 offen offset:2048
    s_mov_b32 m0, 61440
    s_add_u32 s61, s60, 159744
    s_and_b32 s61, s61, 0x3ffff
    s_or_b32 s61, s61, s3
    s_waitcnt vmcnt(10)
    buffer_load_dwordx4 v228, s[12:15], s61 offen offset:0 nt lds
    s_waitcnt vmcnt(10)
    buffer_load_dwordx4 v229, s[12:15], s61 offen offset:1024 nt lds
    s_waitcnt vmcnt(10)
    buffer_load_dwordx4 v230, s[12:15], s61 offen offset:2048 nt lds
    s_waitcnt vmcnt(10)
    buffer_load_dwordx4 v231, s[12:15], s61 offen offset:3072 nt lds
    buffer_load_dwordx4 v[140:143], v235, s[24:27], s40 offen offset:3072
    s_mov_b32 m0, 81920
    s_add_u32 s61, s60, 163840
    s_and_b32 s61, s61, 0x3ffff
    s_or_b32 s61, s61, s3
    s_waitcnt vmcnt(10)
    buffer_load_dwordx4 v228, s[12:15], s61 offen offset:0 nt lds
    s_waitcnt vmcnt(10)
    buffer_load_dwordx4 v229, s[12:15], s61 offen offset:1024 nt lds
    s_waitcnt vmcnt(10)
    buffer_load_dwordx4 v230, s[12:15], s61 offen offset:2048 nt lds
    s_waitcnt vmcnt(10)
    buffer_load_dwordx4 v231, s[12:15], s61 offen offset:3072 nt lds
    s_add_u32 s40, s50, 1024
    buffer_load_dwordx4 v[144:147], v232, s[24:27], s40 offen offset:0
    s_mov_b32 m0, 86016
    s_add_u32 s61, s60, 167936
    s_and_b32 s61, s61, 0x3ffff
    s_or_b32 s61, s61, s3
    s_waitcnt vmcnt(10)
    buffer_load_dwordx4 v228, s[12:15], s61 offen offset:0 nt lds
    s_waitcnt vmcnt(10)
    buffer_load_dwordx4 v229, s[12:15], s61 offen offset:1024 nt lds
    s_waitcnt vmcnt(10)
    buffer_load_dwordx4 v230, s[12:15], s61 offen offset:2048 nt lds
    s_waitcnt vmcnt(10)
    buffer_load_dwordx4 v231, s[12:15], s61 offen offset:3072 nt lds
    buffer_load_dwordx4 v[148:151], v233, s[24:27], s40 offen offset:1024
    s_waitcnt vmcnt(11)
    s_barrier
    s_mov_b32 m0, 90112
    s_add_u32 s61, s60, 172032
    s_and_b32 s61, s61, 0x3ffff
    s_or_b32 s61, s61, s3
    s_waitcnt vmcnt(10)
    buffer_load_dwordx4 v228, s[12:15], s61 offen offset:0 nt lds
    s_waitcnt vmcnt(10)
    buffer_load_dwordx4 v229, s[12:15], s61 offen offset:1024 nt lds
    s_waitcnt vmcnt(10)
    buffer_load_dwordx4 v230, s[12:15], s61 offen offset:2048 nt lds
    s_waitcnt vmcnt(10)
    buffer_load_dwordx4 v231, s[12:15], s61 offen offset:3072 nt lds
    buffer_load_dwordx4 v[152:155], v234, s[24:27], s40 offen offset:2048
    s_mov_b32 m0, 94208
    s_add_u32 s61, s60, 176128
    s_and_b32 s61, s61, 0x3ffff
    s_or_b32 s61, s61, s3
    s_waitcnt vmcnt(10)
    buffer_load_dwordx4 v228, s[12:15], s61 offen offset:0 nt lds
    s_waitcnt vmcnt(10)
    buffer_load_dwordx4 v229, s[12:15], s61 offen offset:1024 nt lds
    s_waitcnt vmcnt(10)
    buffer_load_dwordx4 v230, s[12:15], s61 offen offset:2048 nt lds
    s_waitcnt vmcnt(10)
    buffer_load_dwordx4 v231, s[12:15], s61 offen offset:3072 nt lds
    buffer_load_dwordx4 v[156:159], v235, s[24:27], s40 offen offset:3072
    s_mov_b32 m0, 16384
    s_add_u32 s61, s60, 180224
    s_and_b32 s61, s61, 0x3ffff
    s_or_b32 s61, s61, s3
    s_waitcnt vmcnt(10)
    buffer_load_dwordx4 v228, s[12:15], s61 offen offset:0 nt lds
    s_waitcnt vmcnt(10)
    buffer_load_dwordx4 v229, s[12:15], s61 offen offset:1024 nt lds
    s_waitcnt vmcnt(10)
    buffer_load_dwordx4 v230, s[12:15], s61 offen offset:2048 nt lds
    s_waitcnt vmcnt(10)
    buffer_load_dwordx4 v231, s[12:15], s61 offen offset:3072 nt lds
    s_add_u32 s40, s50, 37888
    buffer_load_dwordx4 v[160:163], v232, s[24:27], s40 offen offset:0
    s_mov_b32 m0, 20480
    s_add_u32 s61, s60, 184320
    s_and_b32 s61, s61, 0x3ffff
    s_or_b32 s61, s61, s3
    s_waitcnt vmcnt(10)
    buffer_load_dwordx4 v228, s[12:15], s61 offen offset:0 nt lds
    s_waitcnt vmcnt(10)
    buffer_load_dwordx4 v229, s[12:15], s61 offen offset:1024 nt lds
    s_waitcnt vmcnt(10)
    buffer_load_dwordx4 v230, s[12:15], s61 offen offset:2048 nt lds
    s_waitcnt vmcnt(10)
    buffer_load_dwordx4 v231, s[12:15], s61 offen offset:3072 nt lds
    buffer_load_dwordx4 v[164:167], v233, s[24:27], s40 offen offset:1024
    buffer_load_dword v238, v227, s[24:27], s52 offen
    buffer_load_dwordx2 v[4:5], off, s[16:19], s51 sc1
    s_waitcnt vmcnt(13)
    s_barrier
    s_mov_b32 m0, 24576
    s_add_u32 s61, s60, 188416
    s_and_b32 s61, s61, 0x3ffff
    s_or_b32 s61, s61, s3
    s_waitcnt vmcnt(10)
    buffer_load_dwordx4 v228, s[12:15], s61 offen offset:0 nt lds
    s_waitcnt vmcnt(10)
    buffer_load_dwordx4 v229, s[12:15], s61 offen offset:1024 nt lds
    s_waitcnt vmcnt(10)
    buffer_load_dwordx4 v230, s[12:15], s61 offen offset:2048 nt lds
    s_waitcnt vmcnt(10)
    buffer_load_dwordx4 v231, s[12:15], s61 offen offset:3072 nt lds
    buffer_load_dwordx4 v[168:171], v234, s[24:27], s40 offen offset:2048
    s_mov_b32 m0, 28672
    s_add_u32 s61, s60, 192512
    s_and_b32 s61, s61, 0x3ffff
    s_or_b32 s61, s61, s3
    s_waitcnt vmcnt(10)
    buffer_load_dwordx4 v228, s[12:15], s61 offen offset:0 nt lds
    s_waitcnt vmcnt(10)
    buffer_load_dwordx4 v229, s[12:15], s61 offen offset:1024 nt lds
    s_waitcnt vmcnt(10)
    buffer_load_dwordx4 v230, s[12:15], s61 offen offset:2048 nt lds
    s_waitcnt vmcnt(10)
    buffer_load_dwordx4 v231, s[12:15], s61 offen offset:3072 nt lds
    buffer_load_dwordx4 v[172:175], v235, s[24:27], s40 offen offset:3072
    s_mov_b32 m0, 49152
    s_add_u32 s61, s60, 196608
    s_and_b32 s61, s61, 0x3ffff
    s_or_b32 s61, s61, s3
    s_waitcnt vmcnt(10)
    buffer_load_dwordx4 v228, s[12:15], s61 offen offset:0 nt lds
    s_waitcnt vmcnt(10)
    buffer_load_dwordx4 v229, s[12:15], s61 offen offset:1024 nt lds
    s_waitcnt vmcnt(10)
    buffer_load_dwordx4 v230, s[12:15], s61 offen offset:2048 nt lds
    s_waitcnt vmcnt(10)
    buffer_load_dwordx4 v231, s[12:15], s61 offen offset:3072 nt lds
    s_add_u32 s40, s50, 74752
    buffer_load_dwordx4 v[176:179], v232, s[24:27], s40 offen offset:0
    s_mov_b32 m0, 53248
    s_add_u32 s61, s60, 200704
    s_and_b32 s61, s61, 0x3ffff
    s_or_b32 s61, s61, s3
    s_waitcnt vmcnt(10)
    buffer_load_dwordx4 v228, s[12:15], s61 offen offset:0 nt lds
    s_waitcnt vmcnt(10)
    buffer_load_dwordx4 v229, s[12:15], s61 offen offset:1024 nt lds
    s_waitcnt vmcnt(10)
    buffer_load_dwordx4 v230, s[12:15], s61 offen offset:2048 nt lds
    s_waitcnt vmcnt(10)
    buffer_load_dwordx4 v231, s[12:15], s61 offen offset:3072 nt lds
    buffer_load_dwordx4 v[180:183], v233, s[24:27], s40 offen offset:1024
    s_waitcnt vmcnt(11)
    s_barrier
    s_mov_b32 m0, 57344
    s_add_u32 s61, s60, 204800
    s_and_b32 s61, s61, 0x3ffff
    s_or_b32 s61, s61, s3
    s_waitcnt vmcnt(10)
    buffer_load_dwordx4 v228, s[12:15], s61 offen offset:0 nt lds
    s_waitcnt vmcnt(10)
    buffer_load_dwordx4 v229, s[12:15], s61 offen offset:1024 nt lds
    s_waitcnt vmcnt(10)
    buffer_load_dwordx4 v230, s[12:15], s61 offen offset:2048 nt lds
    s_waitcnt vmcnt(10)
    buffer_load_dwordx4 v231, s[12:15], s61 offen offset:3072 nt lds
    buffer_load_dwordx4 v[184:187], v234, s[24:27], s40 offen offset:2048
    s_mov_b32 m0, 61440
    s_add_u32 s61, s60, 208896
    s_and_b32 s61, s61, 0x3ffff
    s_or_b32 s61, s61, s3
    s_waitcnt vmcnt(10)
    buffer_load_dwordx4 v228, s[12:15], s61 offen offset:0 nt lds
    s_waitcnt vmcnt(10)
    buffer_load_dwordx4 v229, s[12:15], s61 offen offset:1024 nt lds
    s_waitcnt vmcnt(10)
    buffer_load_dwordx4 v230, s[12:15], s61 offen offset:2048 nt lds
    s_waitcnt vmcnt(10)
    buffer_load_dwordx4 v231, s[12:15], s61 offen offset:3072 nt lds
    buffer_load_dwordx4 v[188:191], v235, s[24:27], s40 offen offset:3072
    s_mov_b32 m0, 81920
    s_add_u32 s61, s60, 212992
    s_and_b32 s61, s61, 0x3ffff
    s_or_b32 s61, s61, s3
    s_waitcnt vmcnt(10)
    buffer_load_dwordx4 v228, s[12:15], s61 offen offset:0 nt lds
    s_waitcnt vmcnt(10)
    buffer_load_dwordx4 v229, s[12:15], s61 offen offset:1024 nt lds
    s_waitcnt vmcnt(10)
    buffer_load_dwordx4 v230, s[12:15], s61 offen offset:2048 nt lds
    s_waitcnt vmcnt(10)
    buffer_load_dwordx4 v231, s[12:15], s61 offen offset:3072 nt lds
    s_add_u32 s40, s50, 111616
    buffer_load_dwordx4 v[192:195], v232, s[24:27], s40 offen offset:0
    s_mov_b32 m0, 86016
    s_add_u32 s61, s60, 217088
    s_and_b32 s61, s61, 0x3ffff
    s_or_b32 s61, s61, s3
    s_waitcnt vmcnt(10)
    buffer_load_dwordx4 v228, s[12:15], s61 offen offset:0 nt lds
    s_waitcnt vmcnt(10)
    buffer_load_dwordx4 v229, s[12:15], s61 offen offset:1024 nt lds
    s_waitcnt vmcnt(10)
    buffer_load_dwordx4 v230, s[12:15], s61 offen offset:2048 nt lds
    s_waitcnt vmcnt(10)
    buffer_load_dwordx4 v231, s[12:15], s61 offen offset:3072 nt lds
    buffer_load_dwordx4 v[196:199], v233, s[24:27], s40 offen offset:1024
    s_waitcnt vmcnt(11)
    s_barrier
    s_mov_b32 m0, 90112
    s_add_u32 s61, s60, 221184
    s_and_b32 s61, s61, 0x3ffff
    s_or_b32 s61, s61, s3
    s_waitcnt vmcnt(10)
    buffer_load_dwordx4 v228, s[12:15], s61 offen offset:0 nt lds
    s_waitcnt vmcnt(10)
    buffer_load_dwordx4 v229, s[12:15], s61 offen offset:1024 nt lds
    s_waitcnt vmcnt(10)
    buffer_load_dwordx4 v230, s[12:15], s61 offen offset:2048 nt lds
    s_waitcnt vmcnt(10)
    buffer_load_dwordx4 v231, s[12:15], s61 offen offset:3072 nt lds
    buffer_load_dwordx4 v[200:203], v234, s[24:27], s40 offen offset:2048
    s_mov_b32 m0, 94208
    s_add_u32 s61, s60, 225280
    s_and_b32 s61, s61, 0x3ffff
    s_or_b32 s61, s61, s3
    s_waitcnt vmcnt(10)
    buffer_load_dwordx4 v228, s[12:15], s61 offen offset:0 nt lds
    s_waitcnt vmcnt(10)
    buffer_load_dwordx4 v229, s[12:15], s61 offen offset:1024 nt lds
    s_waitcnt vmcnt(10)
    buffer_load_dwordx4 v230, s[12:15], s61 offen offset:2048 nt lds
    s_waitcnt vmcnt(10)
    buffer_load_dwordx4 v231, s[12:15], s61 offen offset:3072 nt lds
    buffer_load_dwordx4 v[204:207], v235, s[24:27], s40 offen offset:3072
    s_mov_b32 m0, 16384
    s_add_u32 s61, s60, 229376
    s_and_b32 s61, s61, 0x3ffff
    s_or_b32 s61, s61, s3
    s_waitcnt vmcnt(8)
    buffer_load_dwordx4 v228, s[12:15], s61 offen offset:0 nt lds
    s_waitcnt vmcnt(8)
    buffer_load_dwordx4 v229, s[12:15], s61 offen offset:1024 nt lds
    s_waitcnt vmcnt(8)
    buffer_load_dwordx4 v230, s[12:15], s61 offen offset:2048 nt lds
    s_waitcnt vmcnt(8)
    buffer_load_dwordx4 v231, s[12:15], s61 offen offset:3072 nt lds
    s_mov_b32 m0, 20480
    s_add_u32 s61, s60, 233472
    s_and_b32 s61, s61, 0x3ffff
    s_or_b32 s61, s61, s3
    s_waitcnt vmcnt(8)
    buffer_load_dwordx4 v228, s[12:15], s61 offen offset:0 nt lds
    s_waitcnt vmcnt(8)
    buffer_load_dwordx4 v229, s[12:15], s61 offen offset:1024 nt lds
    s_waitcnt vmcnt(8)
    buffer_load_dwordx4 v230, s[12:15], s61 offen offset:2048 nt lds
    s_waitcnt vmcnt(8)
    buffer_load_dwordx4 v231, s[12:15], s61 offen offset:3072 nt lds
    s_waitcnt vmcnt(9)
    s_barrier
    s_mov_b32 m0, 24576
    s_add_u32 s61, s60, 237568
    s_and_b32 s61, s61, 0x3ffff
    s_or_b32 s61, s61, s3
    s_waitcnt vmcnt(8)
    buffer_load_dwordx4 v228, s[12:15], s61 offen offset:0 nt lds
    s_waitcnt vmcnt(8)
    buffer_load_dwordx4 v229, s[12:15], s61 offen offset:1024 nt lds
    s_waitcnt vmcnt(8)
    buffer_load_dwordx4 v230, s[12:15], s61 offen offset:2048 nt lds
    s_waitcnt vmcnt(8)
    buffer_load_dwordx4 v231, s[12:15], s61 offen offset:3072 nt lds
    s_mov_b32 m0, 28672
    s_add_u32 s61, s60, 241664
    s_and_b32 s61, s61, 0x3ffff
    s_or_b32 s61, s61, s3
    s_waitcnt vmcnt(8)
    buffer_load_dwordx4 v228, s[12:15], s61 offen offset:0 nt lds
    s_waitcnt vmcnt(8)
    buffer_load_dwordx4 v229, s[12:15], s61 offen offset:1024 nt lds
    s_waitcnt vmcnt(8)
    buffer_load_dwordx4 v230, s[12:15], s61 offen offset:2048 nt lds
    s_waitcnt vmcnt(8)
    buffer_load_dwordx4 v231, s[12:15], s61 offen offset:3072 nt lds
    s_mov_b32 m0, 49152
    s_add_u32 s61, s60, 245760
    s_and_b32 s61, s61, 0x3ffff
    s_or_b32 s61, s61, s3
    s_waitcnt vmcnt(8)
    buffer_load_dwordx4 v228, s[12:15], s61 offen offset:0 nt lds
    s_waitcnt vmcnt(8)
    buffer_load_dwordx4 v229, s[12:15], s61 offen offset:1024 nt lds
    s_waitcnt vmcnt(8)
    buffer_load_dwordx4 v230, s[12:15], s61 offen offset:2048 nt lds
    s_waitcnt vmcnt(8)
    buffer_load_dwordx4 v231, s[12:15], s61 offen offset:3072 nt lds
    s_mov_b32 m0, 53248
    s_add_u32 s61, s60, 249856
    s_and_b32 s61, s61, 0x3ffff
    s_or_b32 s61, s61, s3
    s_waitcnt vmcnt(8)
    buffer_load_dwordx4 v228, s[12:15], s61 offen offset:0 nt lds
    s_waitcnt vmcnt(8)
    buffer_load_dwordx4 v229, s[12:15], s61 offen offset:1024 nt lds
    s_waitcnt vmcnt(8)
    buffer_load_dwordx4 v230, s[12:15], s61 offen offset:2048 nt lds
    s_waitcnt vmcnt(8)
    buffer_load_dwordx4 v231, s[12:15], s61 offen offset:3072 nt lds
    s_waitcnt vmcnt(8)
    s_barrier
    s_mov_b32 m0, 57344
    s_add_u32 s61, s60, 253952
    s_and_b32 s61, s61, 0x3ffff
    s_or_b32 s61, s61, s3
    s_waitcnt vmcnt(11)
    buffer_load_dwordx4 v228, s[12:15], s61 offen offset:0 nt lds
    s_waitcnt vmcnt(11)
    buffer_load_dwordx4 v229, s[12:15], s61 offen offset:1024 nt lds
    s_waitcnt vmcnt(11)
    buffer_load_dwordx4 v230, s[12:15], s61 offen offset:2048 nt lds
    s_waitcnt vmcnt(11)
    buffer_load_dwordx4 v231, s[12:15], s61 offen offset:3072 nt lds
    s_mov_b32 m0, 61440
    s_add_u32 s61, s60, 258048
    s_and_b32 s61, s61, 0x3ffff
    s_or_b32 s61, s61, s3
    s_waitcnt vmcnt(11)
    buffer_load_dwordx4 v228, s[12:15], s61 offen offset:0 nt lds
    s_waitcnt vmcnt(11)
    buffer_load_dwordx4 v229, s[12:15], s61 offen offset:1024 nt lds
    s_waitcnt vmcnt(11)
    buffer_load_dwordx4 v230, s[12:15], s61 offen offset:2048 nt lds
    s_waitcnt vmcnt(11)
    buffer_load_dwordx4 v231, s[12:15], s61 offen offset:3072 nt lds
L_kv_t:
    s_add_u32 m0, s59, 65536
    s_add_u32 s39, s50, 256
    buffer_load_dwordx4 v232, s[24:27], s39 offen offset:0 lds
    buffer_load_dwordx4 v233, s[24:27], s39 offen offset:1024 lds
    buffer_load_dwordx4 v234, s[24:27], s39 offen offset:2048 lds
    buffer_load_dwordx4 v235, s[24:27], s39 offen offset:3072 lds
    s_add_u32 m0, m0, 4096
    s_add_u32 s39, s39, 36864
    buffer_load_dwordx4 v232, s[24:27], s39 offen offset:0 lds
    buffer_load_dwordx4 v233, s[24:27], s39 offen offset:1024 lds
    buffer_load_dwordx4 v234, s[24:27], s39 offen offset:2048 lds
    buffer_load_dwordx4 v235, s[24:27], s39 offen offset:3072 lds
    s_add_u32 m0, m0, 4096
    s_add_u32 s39, s39, 36864
    buffer_load_dwordx4 v232, s[24:27], s39 offen offset:0 lds
    buffer_load_dwordx4 v233, s[24:27], s39 offen offset:1024 lds
    buffer_load_dwordx4 v234, s[24:27], s39 offen offset:2048 lds
    buffer_load_dwordx4 v235, s[24:27], s39 offen offset:3072 lds
    s_add_u32 m0, m0, 4096
    s_add_u32 s39, s39, 36864
    buffer_load_dwordx4 v232, s[24:27], s39 offen offset:0 lds
    buffer_load_dwordx4 v233, s[24:27], s39 offen offset:1024 lds
    buffer_load_dwordx4 v234, s[24:27], s39 offen offset:2048 lds
    buffer_load_dwordx4 v235, s[24:27], s39 offen offset:3072 lds
    s_waitcnt vmcnt(16)
    s_barrier
    s_mov_b32 s43, 0
L_tagw:
    v_cmp_ne_u32 vcc, 0, v4
    s_cbranch_vccnz L_tagok
    buffer_load_dwordx2 v[4:5], off, s[16:19], s51 sc1
    s_add_u32 s43, s43, 1
    s_cmp_gt_u32 s43, 0x200000
    s_waitcnt vmcnt(0)
    s_cbranch_scc0 L_tagw
L_tagok:
    v_mov_b32 v238, 0
    s_barrier
    s_waitcnt vmcnt(0)
    s_barrier
    ds_write_b64 v238, v[4:5] offset:57344
    s_add_u32 m0, s59, 98304
    s_add_u32 s39, s50, 384
    buffer_load_dwordx4 v232, s[24:27], s39 offen offset:0 lds
    buffer_load_dwordx4 v233, s[24:27], s39 offen offset:1024 lds
    buffer_load_dwordx4 v234, s[24:27], s39 offen offset:2048 lds
    buffer_load_dwordx4 v235, s[24:27], s39 offen offset:3072 lds
    s_add_u32 m0, m0, 4096
    s_add_u32 s39, s39, 36864
    buffer_load_dwordx4 v232, s[24:27], s39 offen offset:0 lds
    buffer_load_dwordx4 v233, s[24:27], s39 offen offset:1024 lds
    buffer_load_dwordx4 v234, s[24:27], s39 offen offset:2048 lds
    buffer_load_dwordx4 v235, s[24:27], s39 offen offset:3072 lds
    s_add_u32 m0, m0, 4096
    s_add_u32 s39, s39, 36864
    buffer_load_dwordx4 v232, s[24:27], s39 offen offset:0 lds
    buffer_load_dwordx4 v233, s[24:27], s39 offen offset:1024 lds
    buffer_load_dwordx4 v234, s[24:27], s39 offen offset:2048 lds
    buffer_load_dwordx4 v235, s[24:27], s39 offen offset:3072 lds
    s_add_u32 m0, m0, 4096
    s_add_u32 s39, s39, 36864
    buffer_load_dwordx4 v232, s[24:27], s39 offen offset:0 lds
    buffer_load_dwordx4 v233, s[24:27], s39 offen offset:1024 lds
    buffer_load_dwordx4 v234, s[24:27], s39 offen offset:2048 lds
    buffer_load_dwordx4 v235, s[24:27], s39 offen offset:3072 lds
    s_waitcnt lgkmcnt(0)
    s_barrier
    v_add_u32 v238, 131072, v237
    ds_write_b128 v238, v[16:19] offset:0
    ds_write_b128 v238, v[20:23] offset:1024
    ds_write_b128 v238, v[24:27] offset:2048
    ds_write_b128 v238, v[28:31] offset:3072
    ds_write_b128 v238, v[32:35] offset:4096
    ds_write_b128 v238, v[36:39] offset:5120
    ds_write_b128 v238, v[40:43] offset:6144
    ds_write_b128 v238, v[44:47] offset:7168
    s_waitcnt vmcnt(0)
    s_barrier
    ds_write_b128 v238, v[48:51] offset:8192
    ds_write_b128 v238, v[52:55] offset:9216
    ds_write_b128 v238, v[56:59] offset:10240
    ds_write_b128 v238, v[60:63] offset:11264
    ds_write_b128 v238, v[64:67] offset:12288
    ds_write_b128 v238, v[68:71] offset:13312
    ds_write_b128 v238, v[72:75] offset:14336
    ds_write_b128 v238, v[76:79] offset:15360
    s_waitcnt lgkmcnt(0)
    s_barrier
    v_add_u32 v238, 32768, v237
    ds_write_b128 v238, v[80:83] offset:0
    ds_write_b128 v238, v[84:87] offset:1024
    ds_write_b128 v238, v[88:91] offset:2048
    ds_write_b128 v238, v[92:95] offset:3072
    ds_write_b128 v238, v[96:99] offset:4096
    ds_write_b128 v238, v[100:103] offset:5120
    ds_write_b128 v238, v[104:107] offset:6144
    ds_write_b128 v238, v[108:111] offset:7168
    s_barrier
    ds_write_b128 v238, v[112:115] offset:8192
    ds_write_b128 v238, v[116:119] offset:9216
    ds_write_b128 v238, v[120:123] offset:10240
    ds_write_b128 v238, v[124:127] offset:11264
    ds_write_b128 v238, v[128:131] offset:12288
    ds_write_b128 v238, v[132:135] offset:13312
    ds_write_b128 v238, v[136:139] offset:14336
    ds_write_b128 v238, v[140:143] offset:15360
    s_waitcnt lgkmcnt(0)
    s_barrier
    v_add_u32 v238, 98304, v237
    ds_write_b128 v238, v[144:147] offset:0
    ds_write_b128 v238, v[148:151] offset:1024
    ds_write_b128 v238, v[152:155] offset:2048
    ds_write_b128 v238, v[156:159] offset:3072
    ds_write_b128 v238, v[160:163] offset:4096
    ds_write_b128 v238, v[164:167] offset:5120
    ds_write_b128 v238, v[168:171] offset:6144
    ds_write_b128 v238, v[172:175] offset:7168
    s_barrier
    ds_write_b128 v238, v[176:179] offset:8192
    ds_write_b128 v238, v[180:183] offset:9216
    ds_write_b128 v238, v[184:187] offset:10240
    ds_write_b128 v238, v[188:191] offset:11264
    ds_write_b128 v238, v[192:195] offset:12288
    ds_write_b128 v238, v[196:199] offset:13312
    ds_write_b128 v238, v[200:203] offset:14336
    ds_write_b128 v238, v[204:207] offset:15360
    s_waitcnt lgkmcnt(0)
    s_barrier
    s_branch L_red_hi
L_wq:
    s_add_u32 m0, s56, 98304
    s_add_u32 s56, s56, 16384
    buffer_load_dwordx4 v240, s[20:23], s55 offen offset:0 lds
    buffer_load_dwordx4 v241, s[20:23], s55 offen offset:1024 lds
    buffer_load_dwordx4 v242, s[20:23], s55 offen offset:2048 lds
    buffer_load_dwordx4 v243, s[20:23], s55 offen offset:3072 lds
    s_and_b32 s56, s56, 0xffff
    s_add_u32 s55, s55, 0x40000
    s_cmp_ge_u32 s55, s7
    s_cselect_b32 s42, s22, 0
    s_sub_u32 s55, s55, s42
    s_lshl_b32 s39, s48, 3
    s_add_u32 s39, s39, 8
    s_load_dwordx2 s[12:13], s[0:1], s39
    s_load_dwordx2 s[24:25], s[0:1], 32
    s_load_dwordx2 s[32:33], s[0:1], 40
    s_load_dwordx2 s[16:17], s[0:1], 48
    s_load_dwordx2 s[28:29], s[0:1], 56
    s_mov_b32 s14, 67108864
    s_mov_b32 s15, 0x20000
    s_mov_b32 s26, 4718592
    s_mov_b32 s27, 0x20000
    s_mov_b32 s34, 1474560
    s_mov_b32 s35, 0x20000
    s_mov_b32 s18, 256
    s_mov_b32 s19, 0x20000
    s_mov_b32 s30, 268435456
    s_mov_b32 s31, 0x20000
    s_lshl_b32 s3, s37, 4
    s_add_u32 s3, s3, s36
    s_lshl_b32 s3, s3, 18
    s_lshr_b32 s60, s2, 3
    s_lshl_b32 s60, s60, 12
    s_waitcnt lgkmcnt(0)
    s_min_u32 s39, s38, 4
    s_lshl_b32 s39, s39, 13
    s_add_u32 s39, s39, 122880
    v_lshlrev_b32 v237, 4, v226
    v_add_u32 v227, s39, v237
    v_and_b32 v208, 15, v226
    v_lshrrev_b32 v225, 4, v226
    v_xor_b32 v224, v208, v225
    v_lshlrev_b32 v224, 4, v224
    v_lshl_add_u32 v208, v208, 8, v224
    v_lshrrev_b32 v225, 2, v226
    v_and_b32 v223, 3, v226
    v_lshlrev_b32 v223, 3, v223
    v_lshl_add_u32 v212, v225, 8, v223
    v_and_b32 v224, 7, v225
    v_lshl_add_u32 v212, v224, 5, v212
    v_add_u32 v203, 4096, v227
    s_lshl_b32 s39, s48, 13
    v_add_u32 v208, s39, v208
    v_add_u32 v212, s39, v212
    s_lshl_b32 s39, s48, 12
    v_add_u32 v227, s39, v227
    v_subrev_u32 v203, s39, v203
    v_xor_b32 v209, 64, v208
    v_xor_b32 v210, 128, v208
    v_xor_b32 v211, 192, v208
    v_xor_b32 v213, 32, v212
    v_xor_b32 v214, 64, v212
    v_xor_b32 v215, 96, v212
    v_xor_b32 v216, 128, v212
    v_xor_b32 v217, 160, v212
    v_xor_b32 v218, 192, v212
    v_xor_b32 v219, 224, v212
    v_lshl_add_u32 v239, v225, 7, v223
    v_bfe_u32 v224, v226, 3, 2
    v_xor_b32 v224, s49, v224
    v_lshl_add_u32 v239, v224, 5, v239
    v_add_u32 v239, 98304, v239
    v_mov_b32 v204, 0x3f803f80
    v_mov_b32 v205, 0x3f803f80
    v_mov_b32 v206, 0x3f803f80
    v_mov_b32 v207, 0x3f803f80
    s_mov_b32 s46, 0x40004000
    v_lshrrev_b32 v223, 3, v226
    v_bfe_u32 v224, v226, 4, 2
    v_bfe_u32 v225, v226, 1, 2
    v_xor_b32 v224, v224, v225
    v_lshlrev_b32 v224, 5, v224
    v_and_b32 v225, 1, v226
    v_lshl_add_u32 v224, v225, 4, v224
    v_mul_u32_u24 v223, 1152, v223
    v_add_u32 v232, v223, v224
    v_add_u32 v233, 8192, v232
    v_add_u32 v234, 16384, v232
    v_add_u32 v235, 24576, v232
    s_mul_i32 s50, s36, 294912
    s_waitcnt vmcnt(4)
    s_barrier
    s_add_u32 m0, s56, 98304
    s_add_u32 s56, s56, 16384
    buffer_load_dwordx4 v240, s[20:23], s55 offen offset:0 lds
    buffer_load_dwordx4 v241, s[20:23], s55 offen offset:1024 lds
    buffer_load_dwordx4 v242, s[20:23], s55 offen offset:2048 lds
    buffer_load_dwordx4 v243, s[20:23], s55 offen offset:3072 lds
    s_and_b32 s56, s56, 0xffff
    s_add_u32 s55, s55, 0x40000
    s_cmp_ge_u32 s55, s7
    s_cselect_b32 s42, s22, 0
    s_sub_u32 s55, s55, s42
    s_add_u32 m0, s56, 98304
    s_add_u32 s56, s56, 16384
    buffer_load_dwordx4 v240, s[20:23], s55 offen offset:0 lds
    buffer_load_dwordx4 v241, s[20:23], s55 offen offset:1024 lds
    buffer_load_dwordx4 v242, s[20:23], s55 offen offset:2048 lds
    buffer_load_dwordx4 v243, s[20:23], s55 offen offset:3072 lds
    s_and_b32 s56, s56, 0xffff
    s_add_u32 s55, s55, 0x40000
    s_cmp_ge_u32 s55, s7
    s_cselect_b32 s42, s22, 0
    s_sub_u32 s55, s55, s42
    s_mov_b32 s43, 1
L_wq_loop:
    s_waitcnt vmcnt(8)
    s_barrier
    s_add_u32 m0, s56, 98304
    s_add_u32 s56, s56, 16384
    buffer_load_dwordx4 v240, s[20:23], s55 offen offset:0 lds
    buffer_load_dwordx4 v241, s[20:23], s55 offen offset:1024 lds
    buffer_load_dwordx4 v242, s[20:23], s55 offen offset:2048 lds
    buffer_load_dwordx4 v243, s[20:23], s55 offen offset:3072 lds
    s_and_b32 s56, s56, 0xffff
    s_add_u32 s55, s55, 0x40000
    s_cmp_ge_u32 s55, s7
    s_cselect_b32 s42, s22, 0
    s_sub_u32 s55, s55, s42
    s_add_u32 s43, s43, 1
    s_cmp_lt_u32 s43, 15
    s_cbranch_scc1 L_wq_loop
    s_waitcnt vmcnt(8)
    s_barrier
    s_waitcnt vmcnt(4)
    s_barrier
    s_waitcnt vmcnt(0)
    s_barrier
    s_barrier
    s_mul_i32 s39, s48, 147456
    s_add_u32 s52, s50, s39
    s_lshl_b32 s53, s48, 14
    s_add_u32 s53, s53, 98304
    v_mov_b32 v0, 0
    v_mov_b32 v1, 0
    v_mov_b32 v2, 0
    v_mov_b32 v3, 0
    v_mov_b32 v4, 0
    v_mov_b32 v5, 0
    v_mov_b32 v6, 0
    v_mov_b32 v7, 0
    v_mov_b32 v8, 0
    v_mov_b32 v9, 0
    v_mov_b32 v10, 0
    v_mov_b32 v11, 0
    v_mov_b32 v12, 0
    v_mov_b32 v13, 0
    v_mov_b32 v14, 0
    v_mov_b32 v15, 0
    v_mov_b32 v16, 0
    v_mov_b32 v17, 0
    v_mov_b32 v18, 0
    v_mov_b32 v19, 0
    v_mov_b32 v20, 0
    v_mov_b32 v21, 0
    v_mov_b32 v22, 0
    v_mov_b32 v23, 0
    v_mov_b32 v24, 0
    v_mov_b32 v25, 0
    v_mov_b32 v26, 0
    v_mov_b32 v27, 0
    v_mov_b32 v28, 0
    v_mov_b32 v29, 0
    v_mov_b32 v30, 0
    v_mov_b32 v31, 0
    v_mov_b32 v32, 0
    v_mov_b32 v33, 0
    v_mov_b32 v34, 0
    v_mov_b32 v35, 0
    v_mov_b32 v36, 0
    v_mov_b32 v37, 0
    v_mov_b32 v38, 0
    v_mov_b32 v39, 0
    v_mov_b32 v40, 0
    v_mov_b32 v41, 0
    v_mov_b32 v42, 0
    v_mov_b32 v43, 0
    v_mov_b32 v44, 0
    v_mov_b32 v45, 0
    v_mov_b32 v46, 0
    v_mov_b32 v47, 0
    v_mov_b32 v48, 0
    v_mov_b32 v49, 0
    v_mov_b32 v50, 0
    v_mov_b32 v51, 0
    v_mov_b32 v52, 0
    v_mov_b32 v53, 0
    v_mov_b32 v54, 0
    v_mov_b32 v55, 0
    v_mov_b32 v56, 0
    v_mov_b32 v57, 0
    v_mov_b32 v58, 0
    v_mov_b32 v59, 0
    v_mov_b32 v60, 0
    v_mov_b32 v61, 0
    v_mov_b32 v62, 0
    v_mov_b32 v63, 0
    v_mov_b32 v104, 0
    v_mov_b32 v105, 0
    v_mov_b32 v106, 0
    v_mov_b32 v107, 0
    v_mov_b32 v108, 0
    v_mov_b32 v109, 0
    v_mov_b32 v110, 0
    v_mov_b32 v111, 0
    s_setprio 1
    s_barrier
    ds_read_b128 v[64:67], v227 offset:0
    ds_read_b128 v[80:83], v203 offset:0
    ds_read_b128 v[160:163], v208 offset:0
    ds_read_b128 v[68:71], v227 offset:1024
    ds_read_b128 v[84:87], v203 offset:1024
    ds_read_b128 v[164:167], v209 offset:0
    ds_read_b128 v[72:75], v227 offset:2048
    ds_read_b128 v[88:91], v203 offset:2048
    ds_read_b128 v[168:171], v210 offset:0
    ds_read_b128 v[76:79], v227 offset:3072
    ds_read_b128 v[92:95], v203 offset:3072
    ds_read_b128 v[172:175], v211 offset:0
    ds_read_b128 v[176:179], v208 offset:4096
    ds_read_b128 v[180:183], v209 offset:4096
    ds_read_b128 v[184:187], v210 offset:4096
    ds_read_b128 v[188:191], v211 offset:4096
    s_waitcnt lgkmcnt(13)
    v_mfma_f32_16x16x32_bf16 v[112:115], v[160:163], v[64:67], 0
    v_mfma_f32_16x16x32_bf16 v[120:123], v[160:163], v[80:83], 0
    s_waitcnt lgkmcnt(10)
    v_mfma_f32_16x16x32_bf16 v[112:115], v[164:167], v[68:71], v[112:115]
    v_mfma_f32_16x16x32_bf16 v[120:123], v[164:167], v[84:87], v[120:123]
    s_waitcnt lgkmcnt(7)
    v_mfma_f32_16x16x32_bf16 v[112:115], v[168:171], v[72:75], v[112:115]
    v_mfma_f32_16x16x32_bf16 v[120:123], v[168:171], v[88:91], v[120:123]
    s_waitcnt lgkmcnt(4)
    v_mfma_f32_16x16x32_bf16 v[112:115], v[172:175], v[76:79], v[112:115]
    v_mfma_f32_16x16x32_bf16 v[120:123], v[172:175], v[92:95], v[120:123]
    s_waitcnt lgkmcnt(3)
    v_mfma_f32_16x16x32_bf16 v[116:119], v[176:179], v[64:67], 0
    v_mfma_f32_16x16x32_bf16 v[124:127], v[176:179], v[80:83], 0
    s_waitcnt lgkmcnt(2)
    v_mfma_f32_16x16x32_bf16 v[116:119], v[180:183], v[68:71], v[116:119]
    v_mfma_f32_16x16x32_bf16 v[124:127], v[180:183], v[84:87], v[124:127]
    s_waitcnt lgkmcnt(1)
    v_mfma_f32_16x16x32_bf16 v[116:119], v[184:187], v[72:75], v[116:119]
    v_mfma_f32_16x16x32_bf16 v[124:127], v[184:187], v[88:91], v[124:127]
    s_waitcnt lgkmcnt(0)
    v_mfma_f32_16x16x32_bf16 v[116:119], v[188:191], v[76:79], v[116:119]
    v_mfma_f32_16x16x32_bf16 v[124:127], v[188:191], v[92:95], v[124:127]
    s_barrier
    s_mov_b32 s43, 1
    v_add_u32 v208, 32768, v208
    v_add_u32 v209, 32768, v209
    v_add_u32 v210, 32768, v210
    v_add_u32 v211, 32768, v211
    v_add_u32 v212, 32768, v212
    v_add_u32 v213, 32768, v213
    v_add_u32 v214, 32768, v214
    v_add_u32 v215, 32768, v215
    v_add_u32 v216, 32768, v216
    v_add_u32 v217, 32768, v217
    v_add_u32 v218, 32768, v218
    v_add_u32 v219, 32768, v219
    v_max3_f32 v222, v112, v113, v114
    v_max3_f32 v222, v222, v115, v116
    v_max3_f32 v222, v222, v117, v118
    v_max_f32 v222, v222, v119
    v_max3_f32 v201, v120, v121, v122
    v_max3_f32 v201, v201, v123, v124
    v_max3_f32 v201, v201, v125, v126
    v_max_f32 v201, v201, v127
    v_mov_b32 v223, v222
    v_mov_b32 v202, v201
    s_nop 1
    v_permlane16_swap_b32 v222, v223
    v_permlane16_swap_b32 v201, v202
    s_nop 1
    v_max_f32 v222, v222, v223
    v_max_f32 v201, v201, v202
    v_mov_b32 v223, v222
    v_mov_b32 v202, v201
    s_nop 1
    v_permlane32_swap_b32 v222, v223
    v_permlane32_swap_b32 v201, v202
    s_nop 1
    v_max_f32 v222, v222, v223
    v_max_f32 v201, v201, v202
    v_add_f32 v222, 0x41800000, v222
    v_add_f32 v201, 0x41800000, v201
    v_sub_f32 v96, 0, v222
    v_sub_f32 v97, 0, v222
    v_sub_f32 v98, 0, v222
    v_sub_f32 v99, 0, v222
    v_sub_f32 v100, 0, v201
    v_sub_f32 v101, 0, v201
    v_sub_f32 v102, 0, v201
    v_sub_f32 v103, 0, v201
    v_sub_f32 v112, v112, v222
    v_sub_f32 v113, v113, v222
    v_sub_f32 v114, v114, v222
    v_sub_f32 v115, v115, v222
    v_sub_f32 v116, v116, v222
    v_sub_f32 v117, v117, v222
    v_sub_f32 v118, v118, v222
    v_sub_f32 v119, v119, v222
    v_sub_f32 v120, v120, v201
    v_sub_f32 v121, v121, v201
    v_sub_f32 v122, v122, v201
    v_sub_f32 v123, v123, v201
    v_sub_f32 v124, v124, v201
    v_sub_f32 v125, v125, v201
    v_sub_f32 v126, v126, v201
    v_sub_f32 v127, v127, v201
    v_exp_f32 v192, v112
    v_exp_f32 v193, v113
    v_exp_f32 v194, v114
    v_cvt_pk_bf16_f32 v144, v192, v193
    v_exp_f32 v195, v115
    v_exp_f32 v196, v116
    v_cvt_pk_bf16_f32 v145, v194, v195
    v_exp_f32 v197, v117
    v_exp_f32 v198, v118
    v_cvt_pk_bf16_f32 v146, v196, v197
    v_exp_f32 v199, v119
    v_exp_f32 v192, v120
    v_cvt_pk_bf16_f32 v147, v198, v199
    v_exp_f32 v193, v121
    v_exp_f32 v194, v122
    v_cvt_pk_bf16_f32 v148, v192, v193
    v_exp_f32 v195, v123
    v_exp_f32 v196, v124
    v_cvt_pk_bf16_f32 v149, v194, v195
    v_exp_f32 v197, v125
    v_exp_f32 v198, v126
    v_cvt_pk_bf16_f32 v150, v196, v197
    v_exp_f32 v199, v127
    s_nop 0
    v_cvt_pk_bf16_f32 v151, v198, v199
    s_nop 1
    v_mfma_f32_16x16x32_bf16 v[104:107], v[204:207], v[144:147], v[104:107]
    v_mfma_f32_16x16x32_bf16 v[108:111], v[204:207], v[148:151], v[108:111]
L_sm_loop:
    s_barrier
    ds_read_b128 v[160:163], v208 offset:0
    ds_read_b128 v[164:167], v209 offset:0
    ds_read_b128 v[168:171], v210 offset:0
    ds_read_b128 v[172:175], v211 offset:0
    ds_read_b128 v[176:179], v208 offset:4096
    ds_read_b128 v[180:183], v209 offset:4096
    ds_read_b128 v[184:187], v210 offset:4096
    s_cmp_gt_u32 s43, 8
    s_cbranch_scc1 L_sm_now1
    s_mov_b32 m0, s53
    s_cmp_eq_u32 s43, 4
    buffer_load_dwordx4 v232, s[24:27], s52 offen offset:0 lds
    buffer_load_dwordx4 v233, s[24:27], s52 offen offset:1024 lds
    buffer_load_dwordx4 v234, s[24:27], s52 offen offset:2048 lds
    buffer_load_dwordx4 v235, s[24:27], s52 offen offset:3072 lds
    s_cselect_b32 s39, 0xfffdc080, 0
    s_cselect_b32 s40, 16384, 0
    s_add_u32 s52, s52, s39
    s_add_u32 s53, s53, s40
    s_add_u32 s52, s52, 36864
    s_add_u32 s53, s53, 4096
L_sm_now1:
    s_bitcmp1_b32 0x4924, s43
    s_mov_b32 s51, 32768
    s_cselect_b32 s51, 0xffff0000, s51
    s_add_u32 s43, s43, 1
    s_cmp_eq_u32 s43, 16
    s_waitcnt lgkmcnt(5)
    v_mfma_f32_16x16x32_bf16 v[128:131], v[160:163], v[64:67], v[96:99]
    ds_read_b128 v[188:191], v211 offset:4096
    v_mfma_f32_16x16x32_bf16 v[136:139], v[160:163], v[80:83], v[100:103]
    v_mfma_f32_16x16x32_bf16 v[128:131], v[164:167], v[68:71], v[128:131]
    ds_read_b64_tr_b16 v[160:161], v212 offset:16384
    ds_read_b64_tr_b16 v[162:163], v212 offset:20480
    v_mfma_f32_16x16x32_bf16 v[136:139], v[164:167], v[84:87], v[136:139]
    s_waitcnt lgkmcnt(6)
    v_add_u32 v208, s51, v208
    v_add_u32 v209, s51, v209
    v_mfma_f32_16x16x32_bf16 v[128:131], v[168:171], v[72:75], v[128:131]
    ds_read_b64_tr_b16 v[164:165], v213 offset:16384
    ds_read_b64_tr_b16 v[166:167], v213 offset:20480
    v_mfma_f32_16x16x32_bf16 v[136:139], v[168:171], v[88:91], v[136:139]
    v_add_u32 v210, s51, v210
    v_add_u32 v211, s51, v211
    v_mfma_f32_16x16x32_bf16 v[128:131], v[172:175], v[76:79], v[128:131]
    ds_read_b64_tr_b16 v[168:169], v214 offset:16384
    ds_read_b64_tr_b16 v[170:171], v214 offset:20480
    v_mfma_f32_16x16x32_bf16 v[136:139], v[172:175], v[92:95], v[136:139]
    s_waitcnt lgkmcnt(8)
    v_add_u32 v212, s51, v212
    v_add_u32 v213, s51, v213
    v_mfma_f32_16x16x32_bf16 v[132:135], v[176:179], v[64:67], v[96:99]
    ds_read_b64_tr_b16 v[172:173], v215 offset:16384
    ds_read_b64_tr_b16 v[174:175], v215 offset:20480
    v_mfma_f32_16x16x32_bf16 v[140:143], v[176:179], v[80:83], v[100:103]
    v_add_u32 v214, s51, v214
    v_add_u32 v215, s51, v215
    v_mfma_f32_16x16x32_bf16 v[132:135], v[180:183], v[68:71], v[132:135]
    ds_read_b64_tr_b16 v[176:177], v216 offset:16384
    ds_read_b64_tr_b16 v[178:179], v216 offset:20480
    v_mfma_f32_16x16x32_bf16 v[140:143], v[180:183], v[84:87], v[140:143]
    s_waitcnt lgkmcnt(10)
    v_add_u32 v216, s51, v216
    v_mfma_f32_16x16x32_bf16 v[132:135], v[184:187], v[72:75], v[132:135]
    ds_read_b64_tr_b16 v[180:181], v217 offset:16384
    ds_read_b64_tr_b16 v[182:183], v217 offset:20480
    v_mfma_f32_16x16x32_bf16 v[140:143], v[184:187], v[88:91], v[140:143]
    v_exp_f32 v192, v128
    v_mfma_f32_16x16x32_bf16 v[132:135], v[188:191], v[76:79], v[132:135]
    ds_read_b64_tr_b16 v[184:185], v218 offset:16384
    ds_read_b64_tr_b16 v[186:187], v218 offset:20480
    v_mfma_f32_16x16x32_bf16 v[140:143], v[188:191], v[92:95], v[140:143]
    s_waitcnt lgkmcnt(10)
    v_exp_f32 v193, v129
    v_mfma_f32_16x16x32_bf16 v[0:3], v[160:163], v[144:147], v[0:3]
    ds_read_b64_tr_b16 v[188:189], v219 offset:16384
    ds_read_b64_tr_b16 v[190:191], v219 offset:20480
    v_mfma_f32_16x16x32_bf16 v[32:35], v[160:163], v[148:151], v[32:35]
    v_exp_f32 v194, v130
    v_mfma_f32_16x16x32_bf16 v[4:7], v[164:167], v[144:147], v[4:7]
    v_exp_f32 v195, v131
    v_mfma_f32_16x16x32_bf16 v[36:39], v[164:167], v[148:151], v[36:39]
    s_waitcnt lgkmcnt(8)
    v_cvt_pk_bf16_f32 v152, v192, v193
    v_add_u32 v217, s51, v217
    v_mfma_f32_16x16x32_bf16 v[8:11], v[168:171], v[144:147], v[8:11]
    v_exp_f32 v196, v132
    v_mfma_f32_16x16x32_bf16 v[40:43], v[168:171], v[148:151], v[40:43]
    v_exp_f32 v197, v133
    v_cvt_pk_bf16_f32 v153, v194, v195
    v_mfma_f32_16x16x32_bf16 v[12:15], v[172:175], v[144:147], v[12:15]
    v_exp_f32 v198, v134
    v_mfma_f32_16x16x32_bf16 v[44:47], v[172:175], v[148:151], v[44:47]
    s_waitcnt lgkmcnt(4)
    v_exp_f32 v199, v135
    v_cvt_pk_bf16_f32 v154, v196, v197
    v_mfma_f32_16x16x32_bf16 v[16:19], v[176:179], v[144:147], v[16:19]
    v_exp_f32 v192, v136
    v_mfma_f32_16x16x32_bf16 v[48:51], v[176:179], v[148:151], v[48:51]
    v_exp_f32 v193, v137
    v_cvt_pk_bf16_f32 v155, v198, v199
    v_mfma_f32_16x16x32_bf16 v[20:23], v[180:183], v[144:147], v[20:23]
    v_exp_f32 v194, v138
    v_mfma_f32_16x16x32_bf16 v[52:55], v[180:183], v[148:151], v[52:55]
    s_waitcnt lgkmcnt(0)
    v_exp_f32 v195, v139
    v_cvt_pk_bf16_f32 v156, v192, v193
    v_mfma_f32_16x16x32_bf16 v[24:27], v[184:187], v[144:147], v[24:27]
    v_exp_f32 v196, v140
    v_mfma_f32_16x16x32_bf16 v[56:59], v[184:187], v[148:151], v[56:59]
    v_exp_f32 v197, v141
    v_cvt_pk_bf16_f32 v157, v194, v195
    v_mfma_f32_16x16x32_bf16 v[28:31], v[188:191], v[144:147], v[28:31]
    v_exp_f32 v198, v142
    v_mfma_f32_16x16x32_bf16 v[60:63], v[188:191], v[148:151], v[60:63]
    v_exp_f32 v199, v143
    v_cvt_pk_bf16_f32 v158, v196, v197
    v_or3_b32 v221, v152, v153, v154
    v_cvt_pk_bf16_f32 v159, v198, v199
    v_or3_b32 v221, v221, v155, v156
    v_or3_b32 v221, v221, v157, v158
    v_bitop3_b32 v221, v221, v159, s46 bitop3:0xa8
    v_cmp_ne_u32 vcc, 0, v221
    v_add_u32 v218, s51, v218
    v_add_u32 v219, s51, v219
    s_cbranch_vccnz L_tr0
L_bk0:
    v_mfma_f32_16x16x32_bf16 v[104:107], v[204:207], v[152:155], v[104:107]
    v_mfma_f32_16x16x32_bf16 v[108:111], v[204:207], v[156:159], v[108:111]
    s_cbranch_scc1 L_sm_done
    s_barrier
    ds_read_b128 v[160:163], v208 offset:0
    ds_read_b128 v[164:167], v209 offset:0
    ds_read_b128 v[168:171], v210 offset:0
    ds_read_b128 v[172:175], v211 offset:0
    ds_read_b128 v[176:179], v208 offset:4096
    ds_read_b128 v[180:183], v209 offset:4096
    ds_read_b128 v[184:187], v210 offset:4096
    s_cmp_gt_u32 s43, 8
    s_cbranch_scc1 L_sm_now0
    s_mov_b32 m0, s53
    s_cmp_eq_u32 s43, 4
    buffer_load_dwordx4 v232, s[24:27], s52 offen offset:0 lds
    buffer_load_dwordx4 v233, s[24:27], s52 offen offset:1024 lds
    buffer_load_dwordx4 v234, s[24:27], s52 offen offset:2048 lds
    buffer_load_dwordx4 v235, s[24:27], s52 offen offset:3072 lds
    s_cselect_b32 s39, 0xfffdc080, 0
    s_cselect_b32 s40, 16384, 0
    s_add_u32 s52, s52, s39
    s_add_u32 s53, s53, s40
    s_add_u32 s52, s52, 36864
    s_add_u32 s53, s53, 4096
L_sm_now0:
    s_bitcmp1_b32 0x4924, s43
    s_mov_b32 s51, 32768
    s_cselect_b32 s51, 0xffff0000, s51
    s_add_u32 s43, s43, 1
    s_cmp_eq_u32 s43, 16
    s_waitcnt lgkmcnt(5)
    v_mfma_f32_16x16x32_bf16 v[112:115], v[160:163], v[64:67], v[96:99]
    ds_read_b128 v[188:191], v211 offset:4096
    v_mfma_f32_16x16x32_bf16 v[120:123], v[160:163], v[80:83], v[100:103]
    v_mfma_f32_16x16x32_bf16 v[112:115], v[164:167], v[68:71], v[112:115]
    ds_read_b64_tr_b16 v[160:161], v212 offset:16384
    ds_read_b64_tr_b16 v[162:163], v212 offset:20480
    v_mfma_f32_16x16x32_bf16 v[120:123], v[164:167], v[84:87], v[120:123]
    s_waitcnt lgkmcnt(6)
    v_add_u32 v208, s51, v208
    v_add_u32 v209, s51, v209
    v_mfma_f32_16x16x32_bf16 v[112:115], v[168:171], v[72:75], v[112:115]
    ds_read_b64_tr_b16 v[164:165], v213 offset:16384
    ds_read_b64_tr_b16 v[166:167], v213 offset:20480
    v_mfma_f32_16x16x32_bf16 v[120:123], v[168:171], v[88:91], v[120:123]
    v_add_u32 v210, s51, v210
    v_add_u32 v211, s51, v211
    v_mfma_f32_16x16x32_bf16 v[112:115], v[172:175], v[76:79], v[112:115]
    ds_read_b64_tr_b16 v[168:169], v214 offset:16384
    ds_read_b64_tr_b16 v[170:171], v214 offset:20480
    v_mfma_f32_16x16x32_bf16 v[120:123], v[172:175], v[92:95], v[120:123]
    s_waitcnt lgkmcnt(8)
    v_add_u32 v212, s51, v212
    v_add_u32 v213, s51, v213
    v_mfma_f32_16x16x32_bf16 v[116:119], v[176:179], v[64:67], v[96:99]
    ds_read_b64_tr_b16 v[172:173], v215 offset:16384
    ds_read_b64_tr_b16 v[174:175], v215 offset:20480
    v_mfma_f32_16x16x32_bf16 v[124:127], v[176:179], v[80:83], v[100:103]
    v_add_u32 v214, s51, v214
    v_add_u32 v215, s51, v215
    v_mfma_f32_16x16x32_bf16 v[116:119], v[180:183], v[68:71], v[116:119]
    ds_read_b64_tr_b16 v[176:177], v216 offset:16384
    ds_read_b64_tr_b16 v[178:179], v216 offset:20480
    v_mfma_f32_16x16x32_bf16 v[124:127], v[180:183], v[84:87], v[124:127]
    s_waitcnt lgkmcnt(10)
    v_add_u32 v216, s51, v216
    v_mfma_f32_16x16x32_bf16 v[116:119], v[184:187], v[72:75], v[116:119]
    ds_read_b64_tr_b16 v[180:181], v217 offset:16384
    ds_read_b64_tr_b16 v[182:183], v217 offset:20480
    v_mfma_f32_16x16x32_bf16 v[124:127], v[184:187], v[88:91], v[124:127]
    v_exp_f32 v192, v112
    v_mfma_f32_16x16x32_bf16 v[116:119], v[188:191], v[76:79], v[116:119]
    ds_read_b64_tr_b16 v[184:185], v218 offset:16384
    ds_read_b64_tr_b16 v[186:187], v218 offset:20480
    v_mfma_f32_16x16x32_bf16 v[124:127], v[188:191], v[92:95], v[124:127]
    s_waitcnt lgkmcnt(10)
    v_exp_f32 v193, v113
    v_mfma_f32_16x16x32_bf16 v[0:3], v[160:163], v[152:155], v[0:3]
    ds_read_b64_tr_b16 v[188:189], v219 offset:16384
    ds_read_b64_tr_b16 v[190:191], v219 offset:20480
    v_mfma_f32_16x16x32_bf16 v[32:35], v[160:163], v[156:159], v[32:35]
    v_exp_f32 v194, v114
    v_mfma_f32_16x16x32_bf16 v[4:7], v[164:167], v[152:155], v[4:7]
    v_exp_f32 v195, v115
    v_mfma_f32_16x16x32_bf16 v[36:39], v[164:167], v[156:159], v[36:39]
    s_waitcnt lgkmcnt(8)
    v_cvt_pk_bf16_f32 v144, v192, v193
    v_add_u32 v217, s51, v217
    v_mfma_f32_16x16x32_bf16 v[8:11], v[168:171], v[152:155], v[8:11]
    v_exp_f32 v196, v116
    v_mfma_f32_16x16x32_bf16 v[40:43], v[168:171], v[156:159], v[40:43]
    v_exp_f32 v197, v117
    v_cvt_pk_bf16_f32 v145, v194, v195
    v_mfma_f32_16x16x32_bf16 v[12:15], v[172:175], v[152:155], v[12:15]
    v_exp_f32 v198, v118
    v_mfma_f32_16x16x32_bf16 v[44:47], v[172:175], v[156:159], v[44:47]
    s_waitcnt lgkmcnt(4)
    v_exp_f32 v199, v119
    v_cvt_pk_bf16_f32 v146, v196, v197
    v_mfma_f32_16x16x32_bf16 v[16:19], v[176:179], v[152:155], v[16:19]
    v_exp_f32 v192, v120
    v_mfma_f32_16x16x32_bf16 v[48:51], v[176:179], v[156:159], v[48:51]
    v_exp_f32 v193, v121
    v_cvt_pk_bf16_f32 v147, v198, v199
    v_mfma_f32_16x16x32_bf16 v[20:23], v[180:183], v[152:155], v[20:23]
    v_exp_f32 v194, v122
    v_mfma_f32_16x16x32_bf16 v[52:55], v[180:183], v[156:159], v[52:55]
    s_waitcnt lgkmcnt(0)
    v_exp_f32 v195, v123
    v_cvt_pk_bf16_f32 v148, v192, v193
    v_mfma_f32_16x16x32_bf16 v[24:27], v[184:187], v[152:155], v[24:27]
    v_exp_f32 v196, v124
    v_mfma_f32_16x16x32_bf16 v[56:59], v[184:187], v[156:159], v[56:59]
    v_exp_f32 v197, v125
    v_cvt_pk_bf16_f32 v149, v194, v195
    v_mfma_f32_16x16x32_bf16 v[28:31], v[188:191], v[152:155], v[28:31]
    v_exp_f32 v198, v126
    v_mfma_f32_16x16x32_bf16 v[60:63], v[188:191], v[156:159], v[60:63]
    v_exp_f32 v199, v127
    v_cvt_pk_bf16_f32 v150, v196, v197
    v_or3_b32 v221, v144, v145, v146
    v_cvt_pk_bf16_f32 v151, v198, v199
    v_or3_b32 v221, v221, v147, v148
    v_or3_b32 v221, v221, v149, v150
    v_bitop3_b32 v221, v221, v151, s46 bitop3:0xa8
    v_cmp_ne_u32 vcc, 0, v221
    v_add_u32 v218, s51, v218
    v_add_u32 v219, s51, v219
    s_cbranch_vccnz L_tr1
L_bk1:
    v_mfma_f32_16x16x32_bf16 v[104:107], v[204:207], v[144:147], v[104:107]
    v_mfma_f32_16x16x32_bf16 v[108:111], v[204:207], v[148:151], v[108:111]
    s_branch L_sm_loop
L_sm_done:
    s_lshl_b32 s39, s48, 10
    v_add_u32 v224, s39, v237
    v_xor_b32 v225, 1024, v224
    s_lshl_b32 s39, s48, 13
    v_add_u32 v208, s39, v237
    v_xor_b32 v209, 8192, v208
    s_nop 1
    v_mov_b32 v144, v96
    v_mov_b32 v146, v100
    v_mov_b32 v145, v104
    v_mov_b32 v147, v108
    ds_write_b128 v224, v[144:147] offset:32768
    s_waitcnt vmcnt(0) lgkmcnt(0)
    s_barrier
    ds_read_b128 v[148:151], v225 offset:32768
    ds_read_b64_tr_b16 v[160:161], v212 offset:16384
    ds_read_b64_tr_b16 v[162:163], v212 offset:20480
    ds_read_b64_tr_b16 v[164:165], v213 offset:16384
    ds_read_b64_tr_b16 v[166:167], v213 offset:20480
    ds_read_b64_tr_b16 v[168:169], v214 offset:16384
    ds_read_b64_tr_b16 v[170:171], v214 offset:20480
    ds_read_b64_tr_b16 v[172:173], v215 offset:16384
    ds_read_b64_tr_b16 v[174:175], v215 offset:20480
    ds_read_b64_tr_b16 v[176:177], v216 offset:16384
    ds_read_b64_tr_b16 v[178:179], v216 offset:20480
    ds_read_b64_tr_b16 v[180:181], v217 offset:16384
    ds_read_b64_tr_b16 v[182:183], v217 offset:20480
    ds_read_b64_tr_b16 v[184:185], v218 offset:16384
    ds_read_b64_tr_b16 v[186:187], v218 offset:20480
    s_waitcnt lgkmcnt(14)
    v_min_f32 v222, v144, v150
    v_sub_f32 v192, v222, v144
    v_sub_f32 v193, v222, v150
    v_min_f32 v222, v146, v148
    v_sub_f32 v194, v222, v146
    v_sub_f32 v195, v222, v148
    v_exp_f32 v192, v192
    v_exp_f32 v193, v193
    v_exp_f32 v194, v194
    v_exp_f32 v195, v195
    v_mul_f32 v220, v192, v145
    v_mul_f32 v223, v193, v151
    v_add_f32 v220, v220, v223
    v_mul_f32 v200, v194, v147
    v_mul_f32 v223, v195, v149
    v_add_f32 v200, v200, v223
    v_rcp_f32 v220, v220
    v_rcp_f32 v200, v200
    s_nop 0
    v_mul_f32 v220, v220, v192
    v_mul_f32 v200, v200, v194
    ds_read_b64_tr_b16 v[188:189], v219 offset:16384
    ds_read_b64_tr_b16 v[190:191], v219 offset:20480
    s_waitcnt lgkmcnt(14)
    v_mfma_f32_16x16x32_bf16 v[32:35], v[160:163], v[156:159], v[32:35]
    s_waitcnt lgkmcnt(12)
    v_mfma_f32_16x16x32_bf16 v[36:39], v[164:167], v[156:159], v[36:39]
    s_waitcnt lgkmcnt(10)
    v_mfma_f32_16x16x32_bf16 v[40:43], v[168:171], v[156:159], v[40:43]
    s_waitcnt lgkmcnt(8)
    v_mfma_f32_16x16x32_bf16 v[44:47], v[172:175], v[156:159], v[44:47]
    s_waitcnt lgkmcnt(6)
    v_mfma_f32_16x16x32_bf16 v[48:51], v[176:179], v[156:159], v[48:51]
    s_waitcnt lgkmcnt(4)
    v_mfma_f32_16x16x32_bf16 v[52:55], v[180:183], v[156:159], v[52:55]
    s_waitcnt lgkmcnt(2)
    v_mfma_f32_16x16x32_bf16 v[56:59], v[184:187], v[156:159], v[56:59]
    s_waitcnt lgkmcnt(0)
    v_mfma_f32_16x16x32_bf16 v[60:63], v[188:191], v[156:159], v[60:63]
    v_mfma_f32_16x16x32_bf16 v[0:3], v[160:163], v[152:155], v[0:3]
    v_mul_f32 v32, v32, v200
    v_mul_f32 v33, v33, v200
    v_mul_f32 v34, v34, v200
    v_mul_f32 v35, v35, v200
    ds_write_b128 v208, v[32:35] offset:0
    v_mfma_f32_16x16x32_bf16 v[4:7], v[164:167], v[152:155], v[4:7]
    v_mul_f32 v36, v36, v200
    v_mul_f32 v37, v37, v200
    v_mul_f32 v38, v38, v200
    v_mul_f32 v39, v39, v200
    ds_write_b128 v208, v[36:39] offset:1024
    v_mfma_f32_16x16x32_bf16 v[8:11], v[168:171], v[152:155], v[8:11]
    v_mul_f32 v40, v40, v200
    v_mul_f32 v41, v41, v200
    v_mul_f32 v42, v42, v200
    v_mul_f32 v43, v43, v200
    ds_write_b128 v208, v[40:43] offset:2048
    v_mfma_f32_16x16x32_bf16 v[12:15], v[172:175], v[152:155], v[12:15]
    v_mul_f32 v44, v44, v200
    v_mul_f32 v45, v45, v200
    v_mul_f32 v46, v46, v200
    v_mul_f32 v47, v47, v200
    ds_write_b128 v208, v[44:47] offset:3072
    v_mfma_f32_16x16x32_bf16 v[16:19], v[176:179], v[152:155], v[16:19]
    v_mul_f32 v48, v48, v200
    v_mul_f32 v49, v49, v200
    v_mul_f32 v50, v50, v200
    v_mul_f32 v51, v51, v200
    ds_write_b128 v208, v[48:51] offset:4096
    v_mfma_f32_16x16x32_bf16 v[20:23], v[180:183], v[152:155], v[20:23]
    v_mul_f32 v52, v52, v200
    v_mul_f32 v53, v53, v200
    v_mul_f32 v54, v54, v200
    v_mul_f32 v55, v55, v200
    ds_write_b128 v208, v[52:55] offset:5120
    v_mfma_f32_16x16x32_bf16 v[24:27], v[184:187], v[152:155], v[24:27]
    v_mul_f32 v56, v56, v200
    v_mul_f32 v57, v57, v200
    v_mul_f32 v58, v58, v200
    v_mul_f32 v59, v59, v200
    ds_write_b128 v208, v[56:59] offset:6144
    v_mfma_f32_16x16x32_bf16 v[28:31], v[188:191], v[152:155], v[28:31]
    v_mul_f32 v60, v60, v200
    v_mul_f32 v61, v61, v200
    v_mul_f32 v62, v62, v200
    v_mul_f32 v63, v63, v200
    ds_write_b128 v208, v[60:63] offset:7168
    s_waitcnt lgkmcnt(0)
    s_barrier
    s_setprio 0
    ds_read_b128 v[32:35], v209 offset:0
    ds_read_b128 v[36:39], v209 offset:1024
    ds_read_b128 v[40:43], v209 offset:2048
    ds_read_b128 v[44:47], v209 offset:3072
    ds_read_b128 v[48:51], v209 offset:4096
    ds_read_b128 v[52:55], v209 offset:5120
    ds_read_b128 v[56:59], v209 offset:6144
    ds_read_b128 v[60:63], v209 offset:7168
    s_waitcnt lgkmcnt(6)
    v_fma_f32 v0, v0, v220, v32
    v_fma_f32 v1, v1, v220, v33
    v_fma_f32 v2, v2, v220, v34
    v_fma_f32 v3, v3, v220, v35
    v_fma_f32 v4, v4, v220, v36
    v_fma_f32 v5, v5, v220, v37
    v_fma_f32 v6, v6, v220, v38
    v_fma_f32 v7, v7, v220, v39
    v_cvt_pk_bf16_f32 v112, v0, v1
    v_cvt_pk_bf16_f32 v113, v2, v3
    v_cvt_pk_bf16_f32 v114, v4, v5
    v_cvt_pk_bf16_f32 v115, v6, v7
    ds_write_b128 v209, v[112:115] offset:0
    s_waitcnt lgkmcnt(5)
    v_fma_f32 v8, v8, v220, v40
    v_fma_f32 v9, v9, v220, v41
    v_fma_f32 v10, v10, v220, v42
    v_fma_f32 v11, v11, v220, v43
    v_fma_f32 v12, v12, v220, v44
    v_fma_f32 v13, v13, v220, v45
    v_fma_f32 v14, v14, v220, v46
    v_fma_f32 v15, v15, v220, v47
    v_cvt_pk_bf16_f32 v116, v8, v9
    v_cvt_pk_bf16_f32 v117, v10, v11
    v_cvt_pk_bf16_f32 v118, v12, v13
    v_cvt_pk_bf16_f32 v119, v14, v15
    ds_write_b128 v209, v[116:119] offset:1024
    s_waitcnt lgkmcnt(4)
    v_fma_f32 v16, v16, v220, v48
    v_fma_f32 v17, v17, v220, v49
    v_fma_f32 v18, v18, v220, v50
    v_fma_f32 v19, v19, v220, v51
    v_fma_f32 v20, v20, v220, v52
    v_fma_f32 v21, v21, v220, v53
    v_fma_f32 v22, v22, v220, v54
    v_fma_f32 v23, v23, v220, v55
    v_cvt_pk_bf16_f32 v120, v16, v17
    v_cvt_pk_bf16_f32 v121, v18, v19
    v_cvt_pk_bf16_f32 v122, v20, v21
    v_cvt_pk_bf16_f32 v123, v22, v23
    ds_write_b128 v209, v[120:123] offset:2048
    s_waitcnt lgkmcnt(3)
    v_fma_f32 v24, v24, v220, v56
    v_fma_f32 v25, v25, v220, v57
    v_fma_f32 v26, v26, v220, v58
    v_fma_f32 v27, v27, v220, v59
    v_fma_f32 v28, v28, v220, v60
    v_fma_f32 v29, v29, v220, v61
    v_fma_f32 v30, v30, v220, v62
    v_fma_f32 v31, v31, v220, v63
    v_cvt_pk_bf16_f32 v124, v24, v25
    v_cvt_pk_bf16_f32 v125, v26, v27
    v_cvt_pk_bf16_f32 v126, v28, v29
    v_cvt_pk_bf16_f32 v127, v30, v31
    ds_write_b128 v209, v[124:127] offset:3072
    s_waitcnt lgkmcnt(0)
    s_setprio 0
    s_barrier
    v_mov_b32 v238, 0
    s_cmp_eq_u32 s48, 1
    s_barrier
    ds_read_b64 v[4:5], v238 offset:57344
    s_waitcnt lgkmcnt(0)
    s_cbranch_scc1 L_sm_c7
    s_mov_b32 m0, 0
    s_add_u32 s39, s50, 640
    buffer_load_dwordx4 v232, s[24:27], s39 offen offset:0 lds
    buffer_load_dwordx4 v233, s[24:27], s39 offen offset:1024 lds
    buffer_load_dwordx4 v234, s[24:27], s39 offen offset:2048 lds
    buffer_load_dwordx4 v235, s[24:27], s39 offen offset:3072 lds
    s_add_u32 m0, m0, 4096
    s_add_u32 s39, s39, 36864
    buffer_load_dwordx4 v232, s[24:27], s39 offen offset:0 lds
    buffer_load_dwordx4 v233, s[24:27], s39 offen offset:1024 lds
    buffer_load_dwordx4 v234, s[24:27], s39 offen offset:2048 lds
    buffer_load_dwordx4 v235, s[24:27], s39 offen offset:3072 lds
    s_mov_b32 m0, 8192
    s_add_u32 s39, s50, 74368
    buffer_load_dwordx4 v232, s[24:27], s39 offen offset:0 lds
    buffer_load_dwordx4 v233, s[24:27], s39 offen offset:1024 lds
    buffer_load_dwordx4 v234, s[24:27], s39 offen offset:2048 lds
    buffer_load_dwordx4 v235, s[24:27], s39 offen offset:3072 lds
    s_add_u32 m0, m0, 4096
    s_add_u32 s39, s39, 36864
    buffer_load_dwordx4 v232, s[24:27], s39 offen offset:0 lds
    buffer_load_dwordx4 v233, s[24:27], s39 offen offset:1024 lds
    buffer_load_dwordx4 v234, s[24:27], s39 offen offset:2048 lds
    buffer_load_dwordx4 v235, s[24:27], s39 offen offset:3072 lds
    s_barrier
    s_mov_b32 m0, 16384
    s_add_u32 s39, s50, 148096
    buffer_load_dwordx4 v232, s[24:27], s39 offen offset:0 lds
    buffer_load_dwordx4 v233, s[24:27], s39 offen offset:1024 lds
    buffer_load_dwordx4 v234, s[24:27], s39 offen offset:2048 lds
    buffer_load_dwordx4 v235, s[24:27], s39 offen offset:3072 lds
    s_add_u32 m0, m0, 4096
    s_add_u32 s39, s39, 36864
    buffer_load_dwordx4 v232, s[24:27], s39 offen offset:0 lds
    buffer_load_dwordx4 v233, s[24:27], s39 offen offset:1024 lds
    buffer_load_dwordx4 v234, s[24:27], s39 offen offset:2048 lds
    buffer_load_dwordx4 v235, s[24:27], s39 offen offset:3072 lds
    s_mov_b32 m0, 24576
    s_add_u32 s39, s50, 221824
    buffer_load_dwordx4 v232, s[24:27], s39 offen offset:0 lds
    buffer_load_dwordx4 v233, s[24:27], s39 offen offset:1024 lds
    buffer_load_dwordx4 v234, s[24:27], s39 offen offset:2048 lds
    buffer_load_dwordx4 v235, s[24:27], s39 offen offset:3072 lds
    s_add_u32 m0, m0, 4096
    s_add_u32 s39, s39, 36864
    buffer_load_dwordx4 v232, s[24:27], s39 offen offset:0 lds
    buffer_load_dwordx4 v233, s[24:27], s39 offen offset:1024 lds
    buffer_load_dwordx4 v234, s[24:27], s39 offen offset:2048 lds
    buffer_load_dwordx4 v235, s[24:27], s39 offen offset:3072 lds
    s_barrier
    s_waitcnt vmcnt(0)
    s_barrier
    s_barrier
    s_barrier
    s_barrier
    s_branch L_red_hi
L_sm_c7:
    s_barrier
    s_barrier
    s_mov_b32 m0, 65536
    s_add_u32 s39, s50, 896
    buffer_load_dwordx4 v232, s[24:27], s39 offen offset:0 lds
    buffer_load_dwordx4 v233, s[24:27], s39 offen offset:1024 lds
    buffer_load_dwordx4 v234, s[24:27], s39 offen offset:2048 lds
    buffer_load_dwordx4 v235, s[24:27], s39 offen offset:3072 lds
    s_add_u32 m0, m0, 4096
    s_add_u32 s39, s39, 36864
    buffer_load_dwordx4 v232, s[24:27], s39 offen offset:0 lds
    buffer_load_dwordx4 v233, s[24:27], s39 offen offset:1024 lds
    buffer_load_dwordx4 v234, s[24:27], s39 offen offset:2048 lds
    buffer_load_dwordx4 v235, s[24:27], s39 offen offset:3072 lds
    s_mov_b32 m0, 73728
    s_add_u32 s39, s50, 74624
    buffer_load_dwordx4 v232, s[24:27], s39 offen offset:0 lds
    buffer_load_dwordx4 v233, s[24:27], s39 offen offset:1024 lds
    buffer_load_dwordx4 v234, s[24:27], s39 offen offset:2048 lds
    buffer_load_dwordx4 v235, s[24:27], s39 offen offset:3072 lds
    s_add_u32 m0, m0, 4096
    s_add_u32 s39, s39, 36864
    buffer_load_dwordx4 v232, s[24:27], s39 offen offset:0 lds
    buffer_load_dwordx4 v233, s[24:27], s39 offen offset:1024 lds
    buffer_load_dwordx4 v234, s[24:27], s39 offen offset:2048 lds
    buffer_load_dwordx4 v235, s[24:27], s39 offen offset:3072 lds
    s_barrier
    s_mov_b32 m0, 81920
    s_add_u32 s39, s50, 148352
    buffer_load_dwordx4 v232, s[24:27], s39 offen offset:0 lds
    buffer_load_dwordx4 v233, s[24:27], s39 offen offset:1024 lds
    buffer_load_dwordx4 v234, s[24:27], s39 offen offset:2048 lds
    buffer_load_dwordx4 v235, s[24:27], s39 offen offset:3072 lds
    s_add_u32 m0, m0, 4096
    s_add_u32 s39, s39, 36864
    buffer_load_dwordx4 v232, s[24:27], s39 offen offset:0 lds
    buffer_load_dwordx4 v233, s[24:27], s39 offen offset:1024 lds
    buffer_load_dwordx4 v234, s[24:27], s39 offen offset:2048 lds
    buffer_load_dwordx4 v235, s[24:27], s39 offen offset:3072 lds
    s_mov_b32 m0, 90112
    s_add_u32 s39, s50, 222080
    buffer_load_dwordx4 v232, s[24:27], s39 offen offset:0 lds
    buffer_load_dwordx4 v233, s[24:27], s39 offen offset:1024 lds
    buffer_load_dwordx4 v234, s[24:27], s39 offen offset:2048 lds
    buffer_load_dwordx4 v235, s[24:27], s39 offen offset:3072 lds
    s_add_u32 m0, m0, 4096
    s_add_u32 s39, s39, 36864
    buffer_load_dwordx4 v232, s[24:27], s39 offen offset:0 lds
    buffer_load_dwordx4 v233, s[24:27], s39 offen offset:1024 lds
    buffer_load_dwordx4 v234, s[24:27], s39 offen offset:2048 lds
    buffer_load_dwordx4 v235, s[24:27], s39 offen offset:3072 lds
    s_barrier
    s_waitcnt vmcnt(0)
    s_barrier
    s_barrier
L_red_hi:
    s_barrier
    s_lshl_b32 s44, s49, 4
    s_add_u32 s44, s44, s36
    v_mov_b32 v0, v226
    s_cmp_lt_u32 s44, 60
    s_cbranch_scc1 L_reduce
    s_branch L_done
L_qproj:
    s_lshl_b32 s39, s48, 3
    s_add_u32 s39, s39, 8
    s_load_dwordx2 s[12:13], s[0:1], s39
    s_load_dwordx2 s[24:25], s[0:1], 32
    s_load_dwordx2 s[32:33], s[0:1], 40
    s_load_dwordx2 s[16:17], s[0:1], 48
    s_load_dwordx2 s[28:29], s[0:1], 56
    s_mov_b32 s14, 67108864
    s_mov_b32 s15, 0x20000
    s_mov_b32 s26, 4718592
    s_mov_b32 s27, 0x20000
    s_mov_b32 s34, 1474560
    s_mov_b32 s35, 0x20000
    s_mov_b32 s18, 256
    s_mov_b32 s19, 0x20000
    s_mov_b32 s30, 268435456
    s_mov_b32 s31, 0x20000
    s_lshl_b32 s3, s37, 4
    s_add_u32 s3, s3, s36
    s_lshl_b32 s3, s3, 18
    s_lshr_b32 s60, s2, 3
    s_lshl_b32 s60, s60, 12
    s_waitcnt lgkmcnt(0)
    s_cmp_lg_u32 s38, 3
    s_cbranch_scc1 L_q_go
L_q_tag:
    s_cmp_lg_u32 s36, 0
    s_cbranch_scc1 L_q_go
    s_memrealtime s[62:63]
    s_lshl_b32 s39, s37, 3
    v_lshlrev_b32 v254, 8, v0
    s_waitcnt lgkmcnt(0)
    s_or_b32 s40, s62, 1
    v_mov_b32 v252, s40
    v_mov_b32 v253, s63
    buffer_store_dwordx2 v[252:253], v254, s[16:19], s39 offen sc1
L_q_go:
    v_and_b32 v1, 15, v0
    v_lshrrev_b32 v2, 4, v0
    v_lshrrev_b32 v3, 1, v1
    v_xor_b32 v3, v3, v2
    v_lshlrev_b32 v3, 4, v3
    v_lshl_add_u32 v156, v1, 7, v3
    v_xor_b32 v157, 64, v156
    v_bfe_u32 v3, v0, 2, 2
    v_lshl_add_u32 v4, v2, 3, v3
    v_lshlrev_b32 v4, 9, v4
    v_bfe_u32 v3, v0, 2, 3
    s_lshl_b32 s39, s38, 2
    v_xor_b32 v3, s39, v3
    v_lshl_add_u32 v4, v3, 5, v4
    v_and_b32 v3, 3, v0
    v_lshl_add_u32 v152, v3, 3, v4
    v_add_u32 v152, 98304, v152
    v_xor_b32 v153, 32, v152
    v_xor_b32 v154, 64, v152
    v_xor_b32 v155, 96, v152
    s_min_u32 s39, s38, 4
    s_lshl_b32 s39, s39, 13
    s_add_u32 s39, s39, 122880
    v_lshlrev_b32 v237, 4, v226
    v_add_u32 v227, s39, v237
    v_and_b32 v208, 15, v226
    v_lshrrev_b32 v225, 4, v226
    v_xor_b32 v224, v208, v225
    v_lshlrev_b32 v224, 4, v224
    v_lshl_add_u32 v208, v208, 8, v224
    v_lshrrev_b32 v225, 2, v226
    v_and_b32 v223, 3, v226
    v_lshlrev_b32 v223, 3, v223
    v_lshl_add_u32 v212, v225, 8, v223
    v_and_b32 v224, 7, v225
    v_lshl_add_u32 v212, v224, 5, v212
    v_add_u32 v203, 4096, v227
    v_xor_b32 v209, 64, v208
    v_xor_b32 v210, 128, v208
    v_xor_b32 v211, 192, v208
    v_xor_b32 v213, 32, v212
    v_xor_b32 v214, 64, v212
    v_xor_b32 v215, 96, v212
    v_xor_b32 v216, 128, v212
    v_xor_b32 v217, 160, v212
    v_xor_b32 v218, 192, v212
    v_xor_b32 v219, 224, v212
    v_lshl_add_u32 v239, v225, 7, v223
    v_bfe_u32 v224, v226, 3, 2
    v_xor_b32 v224, s49, v224
    v_lshl_add_u32 v239, v224, 5, v239
    v_add_u32 v239, 98304, v239
    v_mov_b32 v204, 0x3f803f80
    v_mov_b32 v205, 0x3f803f80
    v_mov_b32 v206, 0x3f803f80
    v_mov_b32 v207, 0x3f803f80
    s_mov_b32 s46, 0x40004000
    s_lshl_b32 s39, s38, 11
    s_add_u32 s39, s39, 122880
    v_and_b32 v160, 15, v0
    v_lshlrev_b32 v160, 4, v160
    v_bfe_u32 v161, v0, 4, 1
    v_lshl_add_u32 v160, v161, 9, v160
    v_lshrrev_b32 v161, 5, v0
    v_lshl_add_u32 v160, v161, 8, v160
    v_add_u32 v160, s39, v160
    s_mul_i32 s58, s37, 1572864
    s_lshl_b32 s39, s36, 10
    s_add_u32 s58, s58, s39
    s_lshl_b32 s39, s49, 14
    s_add_u32 s58, s58, s39
    s_mul_i32 s45, s37, 2560
    s_lshl_b32 s39, s49, 7
    s_add_u32 s45, s45, s39
    s_lshl_b32 s39, s36, 3
    s_add_u32 s45, s45, s39
    s_add_u32 s45, s45, 100663296
    s_mov_b32 s52, 0x3e0293ee
    s_mov_b32 s53, s52
    v_mov_b32 v0, 0
    v_mov_b32 v1, 0
    v_mov_b32 v2, 0
    v_mov_b32 v3, 0
    v_mov_b32 v4, 0
    v_mov_b32 v5, 0
    v_mov_b32 v6, 0
    v_mov_b32 v7, 0
    v_mov_b32 v8, 0
    v_mov_b32 v9, 0
    v_mov_b32 v10, 0
    v_mov_b32 v11, 0
    v_mov_b32 v12, 0
    v_mov_b32 v13, 0
    v_mov_b32 v14, 0
    v_mov_b32 v15, 0
    v_mov_b32 v16, 0
    v_mov_b32 v17, 0
    v_mov_b32 v18, 0
    v_mov_b32 v19, 0
    v_mov_b32 v20, 0
    v_mov_b32 v21, 0
    v_mov_b32 v22, 0
    v_mov_b32 v23, 0
    v_mov_b32 v24, 0
    v_mov_b32 v25, 0
    v_mov_b32 v26, 0
    v_mov_b32 v27, 0
    v_mov_b32 v28, 0
    v_mov_b32 v29, 0
    v_mov_b32 v30, 0
    v_mov_b32 v31, 0
    v_mov_b32 v32, 0
    v_mov_b32 v33, 0
    v_mov_b32 v34, 0
    v_mov_b32 v35, 0
    v_mov_b32 v36, 0
    v_mov_b32 v37, 0
    v_mov_b32 v38, 0
    v_mov_b32 v39, 0
    v_mov_b32 v40, 0
    v_mov_b32 v41, 0
    v_mov_b32 v42, 0
    v_mov_b32 v43, 0
    v_mov_b32 v44, 0
    v_mov_b32 v45, 0
    v_mov_b32 v46, 0
    v_mov_b32 v47, 0
    v_mov_b32 v48, 0
    v_mov_b32 v49, 0
    v_mov_b32 v50, 0
    v_mov_b32 v51, 0
    v_mov_b32 v52, 0
    v_mov_b32 v53, 0
    v_mov_b32 v54, 0
    v_mov_b32 v55, 0
    v_mov_b32 v56, 0
    v_mov_b32 v57, 0
    v_mov_b32 v58, 0
    v_mov_b32 v59, 0
    v_mov_b32 v60, 0
    v_mov_b32 v61, 0
    v_mov_b32 v62, 0
    v_mov_b32 v63, 0
    v_mov_b32 v64, 0
    v_mov_b32 v65, 0
    v_mov_b32 v66, 0
    v_mov_b32 v67, 0
    v_mov_b32 v68, 0
    v_mov_b32 v69, 0
    v_mov_b32 v70, 0
    v_mov_b32 v71, 0
    v_mov_b32 v72, 0
    v_mov_b32 v73, 0
    v_mov_b32 v74, 0
    v_mov_b32 v75, 0
    v_mov_b32 v76, 0
    v_mov_b32 v77, 0
    v_mov_b32 v78, 0
    v_mov_b32 v79, 0
    s_mov_b32 s43, 0
    s_barrier
    ds_read_b64_tr_b16 v[120:121], v152 offset:0
    ds_read_b64_tr_b16 v[122:123], v152 offset:2048
    ds_read_b64_tr_b16 v[124:125], v153 offset:0
    ds_read_b64_tr_b16 v[126:127], v153 offset:2048
    ds_read_b64_tr_b16 v[128:129], v154 offset:0
    ds_read_b64_tr_b16 v[130:131], v154 offset:2048
    ds_read_b64_tr_b16 v[132:133], v155 offset:0
    ds_read_b64_tr_b16 v[134:135], v155 offset:2048
    ds_read_b128 v[80:83], v156 offset:0
    ds_read_b128 v[84:87], v156 offset:2048
    ds_read_b128 v[88:91], v156 offset:4096
    ds_read_b128 v[92:95], v156 offset:6144
    ds_read_b128 v[96:99], v156 offset:8192
    s_waitcnt lgkmcnt(0)
    s_barrier
    s_branch L_q_mid
L_q_top:
    v_mfma_f32_16x16x32_bf16 v[0:3], v[136:139], v[100:103], v[0:3]
    ds_read_b64_tr_b16 v[120:121], v152 offset:0
    v_mfma_f32_16x16x32_bf16 v[4:7], v[136:139], v[104:107], v[4:7]
    ds_read_b64_tr_b16 v[122:123], v152 offset:2048
    v_mfma_f32_16x16x32_bf16 v[8:11], v[136:139], v[108:111], v[8:11]
    ds_read_b64_tr_b16 v[124:125], v153 offset:0
    v_mfma_f32_16x16x32_bf16 v[12:15], v[136:139], v[112:115], v[12:15]
    ds_read_b64_tr_b16 v[126:127], v153 offset:2048
    v_mfma_f32_16x16x32_bf16 v[16:19], v[136:139], v[116:119], v[16:19]
    ds_read_b64_tr_b16 v[128:129], v154 offset:0
    v_mfma_f32_16x16x32_bf16 v[20:23], v[140:143], v[100:103], v[20:23]
    ds_read_b64_tr_b16 v[130:131], v154 offset:2048
    v_mfma_f32_16x16x32_bf16 v[24:27], v[140:143], v[104:107], v[24:27]
    ds_read_b64_tr_b16 v[132:133], v155 offset:0
    v_mfma_f32_16x16x32_bf16 v[28:31], v[140:143], v[108:111], v[28:31]
    ds_read_b64_tr_b16 v[134:135], v155 offset:2048
    v_mfma_f32_16x16x32_bf16 v[32:35], v[140:143], v[112:115], v[32:35]
    ds_read_b128 v[80:83], v156 offset:0
    v_mfma_f32_16x16x32_bf16 v[36:39], v[140:143], v[116:119], v[36:39]
    ds_read_b128 v[84:87], v156 offset:2048
    v_mfma_f32_16x16x32_bf16 v[40:43], v[144:147], v[100:103], v[40:43]
    ds_read_b128 v[88:91], v156 offset:4096
    v_mfma_f32_16x16x32_bf16 v[44:47], v[144:147], v[104:107], v[44:47]
    ds_read_b128 v[92:95], v156 offset:6144
    v_mfma_f32_16x16x32_bf16 v[48:51], v[144:147], v[108:111], v[48:51]
    ds_read_b128 v[96:99], v156 offset:8192
    v_mfma_f32_16x16x32_bf16 v[52:55], v[144:147], v[112:115], v[52:55]
    v_mfma_f32_16x16x32_bf16 v[56:59], v[144:147], v[116:119], v[56:59]
    v_mfma_f32_16x16x32_bf16 v[60:63], v[148:151], v[100:103], v[60:63]
    v_mfma_f32_16x16x32_bf16 v[64:67], v[148:151], v[104:107], v[64:67]
    v_mfma_f32_16x16x32_bf16 v[68:71], v[148:151], v[108:111], v[68:71]
    v_mfma_f32_16x16x32_bf16 v[72:75], v[148:151], v[112:115], v[72:75]
    v_mfma_f32_16x16x32_bf16 v[76:79], v[148:151], v[116:119], v[76:79]
    s_waitcnt lgkmcnt(0)
    s_barrier
L_q_mid:
    v_mfma_f32_16x16x32_bf16 v[0:3], v[120:123], v[80:83], v[0:3]
    ds_read_b64_tr_b16 v[136:137], v152 offset:16384
    v_mfma_f32_16x16x32_bf16 v[4:7], v[120:123], v[84:87], v[4:7]
    ds_read_b64_tr_b16 v[138:139], v152 offset:18432
    v_mfma_f32_16x16x32_bf16 v[8:11], v[120:123], v[88:91], v[8:11]
    ds_read_b64_tr_b16 v[140:141], v153 offset:16384
    v_mfma_f32_16x16x32_bf16 v[12:15], v[120:123], v[92:95], v[12:15]
    ds_read_b64_tr_b16 v[142:143], v153 offset:18432
    v_mfma_f32_16x16x32_bf16 v[16:19], v[120:123], v[96:99], v[16:19]
    ds_read_b64_tr_b16 v[144:145], v154 offset:16384
    v_mfma_f32_16x16x32_bf16 v[20:23], v[124:127], v[80:83], v[20:23]
    ds_read_b64_tr_b16 v[146:147], v154 offset:18432
    v_mfma_f32_16x16x32_bf16 v[24:27], v[124:127], v[84:87], v[24:27]
    ds_read_b64_tr_b16 v[148:149], v155 offset:16384
    v_mfma_f32_16x16x32_bf16 v[28:31], v[124:127], v[88:91], v[28:31]
    ds_read_b64_tr_b16 v[150:151], v155 offset:18432
    v_mfma_f32_16x16x32_bf16 v[32:35], v[124:127], v[92:95], v[32:35]
    ds_read_b128 v[100:103], v157 offset:0
    v_mfma_f32_16x16x32_bf16 v[36:39], v[124:127], v[96:99], v[36:39]
    ds_read_b128 v[104:107], v157 offset:2048
    v_mfma_f32_16x16x32_bf16 v[40:43], v[128:131], v[80:83], v[40:43]
    ds_read_b128 v[108:111], v157 offset:4096
    v_mfma_f32_16x16x32_bf16 v[44:47], v[128:131], v[84:87], v[44:47]
    ds_read_b128 v[112:115], v157 offset:6144
    v_mfma_f32_16x16x32_bf16 v[48:51], v[128:131], v[88:91], v[48:51]
    ds_read_b128 v[116:119], v157 offset:8192
    v_mfma_f32_16x16x32_bf16 v[52:55], v[128:131], v[92:95], v[52:55]
    s_mov_b32 s39, 10240
    s_bitcmp1_b32 36, s43
    v_mfma_f32_16x16x32_bf16 v[56:59], v[128:131], v[96:99], v[56:59]
    s_cselect_b32 s39, 12288, s39
    s_add_u32 s43, s43, 1
    v_mfma_f32_16x16x32_bf16 v[60:63], v[132:135], v[80:83], v[60:63]
    s_cmp_lt_u32 s43, 9
    v_xor_b32 v152, 0x38000, v152
    v_mfma_f32_16x16x32_bf16 v[64:67], v[132:135], v[84:87], v[64:67]
    v_xor_b32 v153, 0x38000, v153
    v_xor_b32 v154, 0x38000, v154
    v_mfma_f32_16x16x32_bf16 v[68:71], v[132:135], v[88:91], v[68:71]
    v_xor_b32 v155, 0x38000, v155
    v_add_u32 v156, s39, v156
    v_mfma_f32_16x16x32_bf16 v[72:75], v[132:135], v[92:95], v[72:75]
    v_add_u32 v157, s39, v157
    v_mfma_f32_16x16x32_bf16 v[76:79], v[132:135], v[96:99], v[76:79]
    s_waitcnt lgkmcnt(0)
    s_barrier
    s_cbranch_scc1 L_q_top
    v_mfma_f32_16x16x32_bf16 v[0:3], v[136:139], v[100:103], v[0:3]
    s_nop 0
    s_nop 0
    v_mfma_f32_16x16x32_bf16 v[20:23], v[140:143], v[100:103], v[20:23]
    s_nop 0
    s_nop 0
    v_mfma_f32_16x16x32_bf16 v[4:7], v[136:139], v[104:107], v[4:7]
    s_nop 0
    s_nop 0
    v_mfma_f32_16x16x32_bf16 v[24:27], v[140:143], v[104:107], v[24:27]
    v_mul_f32 v0, s52, v0
    v_mul_f32 v1, s52, v1
    v_mfma_f32_16x16x32_bf16 v[8:11], v[136:139], v[108:111], v[8:11]
    v_mul_f32 v2, s52, v2
    v_mul_f32 v3, s52, v3
    v_mfma_f32_16x16x32_bf16 v[28:31], v[140:143], v[108:111], v[28:31]
    v_mul_f32 v20, s52, v20
    v_mul_f32 v21, s52, v21
    v_mfma_f32_16x16x32_bf16 v[12:15], v[136:139], v[112:115], v[12:15]
    v_mul_f32 v22, s52, v22
    v_mul_f32 v23, s52, v23
    v_mfma_f32_16x16x32_bf16 v[32:35], v[140:143], v[112:115], v[32:35]
    v_cvt_pk_bf16_f32 v0, v0, v1
    v_cvt_pk_bf16_f32 v1, v2, v3
    v_mfma_f32_16x16x32_bf16 v[16:19], v[136:139], v[116:119], v[16:19]
    v_cvt_pk_bf16_f32 v2, v20, v21
    v_cvt_pk_bf16_f32 v3, v22, v23
    v_mfma_f32_16x16x32_bf16 v[36:39], v[140:143], v[116:119], v[36:39]
    v_mul_f32 v4, s52, v4
    v_mul_f32 v5, s52, v5
    v_mfma_f32_16x16x32_bf16 v[40:43], v[144:147], v[100:103], v[40:43]
    v_mul_f32 v6, s52, v6
    v_mul_f32 v7, s52, v7
    v_mfma_f32_16x16x32_bf16 v[60:63], v[148:151], v[100:103], v[60:63]
    v_permlane16_swap_b32 v0, v2
    v_permlane16_swap_b32 v1, v3
    v_mfma_f32_16x16x32_bf16 v[44:47], v[144:147], v[104:107], v[44:47]
    ds_write_b128 v160, v[0:3] offset:0
    v_mul_f32 v24, s52, v24
    v_mfma_f32_16x16x32_bf16 v[64:67], v[148:151], v[104:107], v[64:67]
    v_mul_f32 v25, s52, v25
    v_mul_f32 v26, s52, v26
    v_mfma_f32_16x16x32_bf16 v[48:51], v[144:147], v[108:111], v[48:51]
    v_mul_f32 v27, s52, v27
    v_cvt_pk_bf16_f32 v4, v4, v5
    v_mfma_f32_16x16x32_bf16 v[68:71], v[148:151], v[108:111], v[68:71]
    v_cvt_pk_bf16_f32 v5, v6, v7
    v_cvt_pk_bf16_f32 v6, v24, v25
    v_mfma_f32_16x16x32_bf16 v[52:55], v[144:147], v[112:115], v[52:55]
    v_cvt_pk_bf16_f32 v7, v26, v27
    v_mul_f32 v8, s52, v8
    v_mfma_f32_16x16x32_bf16 v[72:75], v[148:151], v[112:115], v[72:75]
    v_mul_f32 v9, s52, v9
    v_mul_f32 v10, s52, v10
    v_mfma_f32_16x16x32_bf16 v[56:59], v[144:147], v[116:119], v[56:59]
    v_mul_f32 v11, s52, v11
    v_permlane16_swap_b32 v4, v6
    v_mfma_f32_16x16x32_bf16 v[76:79], v[148:151], v[116:119], v[76:79]
    v_permlane16_swap_b32 v5, v7
    ds_write_b128 v160, v[4:7] offset:8192
    v_mul_f32 v28, s52, v28
    v_mul_f32 v29, s52, v29
    v_mul_f32 v30, s52, v30
    v_mul_f32 v31, s52, v31
    v_cvt_pk_bf16_f32 v8, v8, v9
    v_cvt_pk_bf16_f32 v9, v10, v11
    v_cvt_pk_bf16_f32 v10, v28, v29
    v_cvt_pk_bf16_f32 v11, v30, v31
    v_mul_f32 v12, s52, v12
    v_mul_f32 v13, s52, v13
    v_mul_f32 v14, s52, v14
    v_mul_f32 v15, s52, v15
    v_permlane16_swap_b32 v8, v10
    v_permlane16_swap_b32 v9, v11
    ds_write_b128 v160, v[8:11] offset:16384
    v_mul_f32 v32, s52, v32
    v_mul_f32 v33, s52, v33
    v_mul_f32 v34, s52, v34
    v_mul_f32 v35, s52, v35
    v_cvt_pk_bf16_f32 v12, v12, v13
    v_cvt_pk_bf16_f32 v13, v14, v15
    v_cvt_pk_bf16_f32 v14, v32, v33
    v_cvt_pk_bf16_f32 v15, v34, v35
    v_mul_f32 v16, s52, v16
    v_mul_f32 v17, s52, v17
    v_mul_f32 v18, s52, v18
    v_mul_f32 v19, s52, v19
    v_permlane16_swap_b32 v12, v14
    v_permlane16_swap_b32 v13, v15
    ds_write_b128 v160, v[12:15] offset:24576
    v_mul_f32 v36, s52, v36
    v_mul_f32 v37, s52, v37
    v_mul_f32 v38, s52, v38
    v_mul_f32 v39, s52, v39
    v_cvt_pk_bf16_f32 v16, v16, v17
    v_cvt_pk_bf16_f32 v17, v18, v19
    v_cvt_pk_bf16_f32 v18, v36, v37
    v_cvt_pk_bf16_f32 v19, v38, v39
    v_mul_f32 v40, s52, v40
    v_mul_f32 v41, s52, v41
    v_mul_f32 v42, s52, v42
    v_mul_f32 v43, s52, v43
    v_permlane16_swap_b32 v16, v18
    v_permlane16_swap_b32 v17, v19
    ds_write_b128 v160, v[16:19] offset:32768
    v_mul_f32 v60, s52, v60
    v_mul_f32 v61, s52, v61
    v_mul_f32 v62, s52, v62
    v_mul_f32 v63, s52, v63
    v_cvt_pk_bf16_f32 v40, v40, v41
    v_cvt_pk_bf16_f32 v41, v42, v43
    v_cvt_pk_bf16_f32 v42, v60, v61
    v_cvt_pk_bf16_f32 v43, v62, v63
    v_mul_f32 v44, s52, v44
    v_mul_f32 v45, s52, v45
    v_mul_f32 v46, s52, v46
    v_mul_f32 v47, s52, v47
    v_permlane16_swap_b32 v40, v42
    v_permlane16_swap_b32 v41, v43
    ds_write_b128 v160, v[40:43] offset:1024
    v_mul_f32 v64, s52, v64
    v_mul_f32 v65, s52, v65
    v_mul_f32 v66, s52, v66
    v_mul_f32 v67, s52, v67
    v_cvt_pk_bf16_f32 v44, v44, v45
    v_cvt_pk_bf16_f32 v45, v46, v47
    v_cvt_pk_bf16_f32 v46, v64, v65
    v_cvt_pk_bf16_f32 v47, v66, v67
    v_mul_f32 v48, s52, v48
    v_mul_f32 v49, s52, v49
    v_mul_f32 v50, s52, v50
    v_mul_f32 v51, s52, v51
    v_permlane16_swap_b32 v44, v46
    v_permlane16_swap_b32 v45, v47
    ds_write_b128 v160, v[44:47] offset:9216
    v_mul_f32 v68, s52, v68
    v_mul_f32 v69, s52, v69
    v_mul_f32 v70, s52, v70
    v_mul_f32 v71, s52, v71
    v_cvt_pk_bf16_f32 v48, v48, v49
    v_cvt_pk_bf16_f32 v49, v50, v51
    v_cvt_pk_bf16_f32 v50, v68, v69
    v_cvt_pk_bf16_f32 v51, v70, v71
    v_mul_f32 v52, s52, v52
    v_mul_f32 v53, s52, v53
    v_mul_f32 v54, s52, v54
    v_mul_f32 v55, s52, v55
    v_permlane16_swap_b32 v48, v50
    v_permlane16_swap_b32 v49, v51
    ds_write_b128 v160, v[48:51] offset:17408
    v_mul_f32 v72, s52, v72
    v_mul_f32 v73, s52, v73
    v_mul_f32 v74, s52, v74
    v_mul_f32 v75, s52, v75
    v_cvt_pk_bf16_f32 v52, v52, v53
    v_cvt_pk_bf16_f32 v53, v54, v55
    v_cvt_pk_bf16_f32 v54, v72, v73
    v_cvt_pk_bf16_f32 v55, v74, v75
    v_mul_f32 v56, s52, v56
    v_mul_f32 v57, s52, v57
    v_mul_f32 v58, s52, v58
    v_mul_f32 v59, s52, v59
    v_permlane16_swap_b32 v52, v54
    v_permlane16_swap_b32 v53, v55
    ds_write_b128 v160, v[52:55] offset:25600
    v_mul_f32 v76, s52, v76
    v_mul_f32 v77, s52, v77
    v_mul_f32 v78, s52, v78
    v_mul_f32 v79, s52, v79
    v_cvt_pk_bf16_f32 v56, v56, v57
    v_cvt_pk_bf16_f32 v57, v58, v59
    v_cvt_pk_bf16_f32 v58, v76, v77
    v_cvt_pk_bf16_f32 v59, v78, v79
    s_nop 1
    v_permlane16_swap_b32 v56, v58
    v_permlane16_swap_b32 v57, v59
    ds_write_b128 v160, v[56:59] offset:33792
    s_waitcnt vmcnt(0) lgkmcnt(0)
L_attn:
    s_barrier
    ds_read_b128 v[64:67], v227 offset:0
    ds_read_b128 v[80:83], v203 offset:0
    ds_read_b128 v[160:163], v208 offset:0
    ds_read_b128 v[68:71], v227 offset:1024
    ds_read_b128 v[84:87], v203 offset:1024
    ds_read_b128 v[164:167], v209 offset:0
    ds_read_b128 v[72:75], v227 offset:2048
    ds_read_b128 v[88:91], v203 offset:2048
    ds_read_b128 v[168:171], v210 offset:0
    ds_read_b128 v[76:79], v227 offset:3072
    ds_read_b128 v[92:95], v203 offset:3072
    ds_read_b128 v[172:175], v211 offset:0
    ds_read_b128 v[176:179], v208 offset:4096
    ds_read_b128 v[180:183], v209 offset:4096
    ds_read_b128 v[184:187], v210 offset:4096
    ds_read_b128 v[188:191], v211 offset:4096
    v_mov_b32 v111, 0
    v_mov_b32 v110, 0
    v_mov_b32 v109, 0
    v_mov_b32 v108, 0
    v_mov_b32 v107, 0
    v_mov_b32 v106, 0
    v_mov_b32 v105, 0
    v_mov_b32 v104, 0
    v_mov_b32 v63, 0
    v_mov_b32 v62, 0
    v_mov_b32 v61, 0
    v_mov_b32 v60, 0
    v_mov_b32 v59, 0
    v_mov_b32 v58, 0
    v_mov_b32 v57, 0
    v_mov_b32 v56, 0
    v_mov_b32 v55, 0
    v_mov_b32 v54, 0
    v_mov_b32 v53, 0
    v_mov_b32 v52, 0
    v_mov_b32 v51, 0
    v_mov_b32 v50, 0
    v_mov_b32 v49, 0
    v_mov_b32 v48, 0
    s_waitcnt lgkmcnt(13)
    v_mfma_f32_16x16x32_bf16 v[112:115], v[160:163], v[64:67], 0
    v_mov_b32 v47, 0
    v_mfma_f32_16x16x32_bf16 v[120:123], v[160:163], v[80:83], 0
    v_mov_b32 v46, 0
    v_mov_b32 v45, 0
    v_mov_b32 v44, 0
    s_waitcnt lgkmcnt(10)
    v_mfma_f32_16x16x32_bf16 v[112:115], v[164:167], v[68:71], v[112:115]
    ds_read_b128 v[160:163], v208 offset:8192
    v_mov_b32 v43, 0
    v_mfma_f32_16x16x32_bf16 v[120:123], v[164:167], v[84:87], v[120:123]
    v_mov_b32 v42, 0
    v_mov_b32 v41, 0
    v_mov_b32 v40, 0
    s_waitcnt lgkmcnt(8)
    v_mfma_f32_16x16x32_bf16 v[112:115], v[168:171], v[72:75], v[112:115]
    ds_read_b128 v[164:167], v209 offset:8192
    v_mov_b32 v39, 0
    v_mfma_f32_16x16x32_bf16 v[120:123], v[168:171], v[88:91], v[120:123]
    v_mov_b32 v38, 0
    v_mov_b32 v37, 0
    v_mov_b32 v36, 0
    s_waitcnt lgkmcnt(6)
    v_mfma_f32_16x16x32_bf16 v[112:115], v[172:175], v[76:79], v[112:115]
    ds_read_b128 v[168:171], v210 offset:8192
    v_mov_b32 v35, 0
    v_mfma_f32_16x16x32_bf16 v[120:123], v[172:175], v[92:95], v[120:123]
    v_mov_b32 v34, 0
    v_mov_b32 v33, 0
    v_mov_b32 v32, 0
    s_waitcnt lgkmcnt(6)
    v_mfma_f32_16x16x32_bf16 v[116:119], v[176:179], v[64:67], 0
    ds_read_b128 v[172:175], v211 offset:8192
    v_mov_b32 v31, 0
    v_mfma_f32_16x16x32_bf16 v[124:127], v[176:179], v[80:83], 0
    v_mov_b32 v30, 0
    v_mov_b32 v29, 0
    v_mov_b32 v28, 0
    s_waitcnt lgkmcnt(6)
    v_mfma_f32_16x16x32_bf16 v[116:119], v[180:183], v[68:71], v[116:119]
    ds_read_b128 v[176:179], v208 offset:12288
    v_mov_b32 v27, 0
    v_mfma_f32_16x16x32_bf16 v[124:127], v[180:183], v[84:87], v[124:127]
    v_mov_b32 v26, 0
    v_mov_b32 v25, 0
    v_mov_b32 v24, 0
    s_waitcnt lgkmcnt(6)
    v_mfma_f32_16x16x32_bf16 v[116:119], v[184:187], v[72:75], v[116:119]
    ds_read_b128 v[180:183], v209 offset:12288
    v_mov_b32 v23, 0
    v_mfma_f32_16x16x32_bf16 v[124:127], v[184:187], v[88:91], v[124:127]
    v_mov_b32 v22, 0
    v_mov_b32 v21, 0
    v_mov_b32 v20, 0
    s_waitcnt lgkmcnt(6)
    v_mfma_f32_16x16x32_bf16 v[116:119], v[188:191], v[76:79], v[116:119]
    ds_read_b128 v[184:187], v210 offset:12288
    v_mov_b32 v19, 0
    v_mfma_f32_16x16x32_bf16 v[124:127], v[188:191], v[92:95], v[124:127]
    v_mov_b32 v18, 0
    v_mov_b32 v17, 0
    v_mov_b32 v16, 0
    ds_read_b128 v[188:191], v211 offset:12288
    s_barrier
    v_mov_b32 v15, 0
    v_mov_b32 v14, 0
    v_mov_b32 v13, 0
    v_mov_b32 v12, 0
    v_mov_b32 v11, 0
    v_mov_b32 v10, 0
    v_mov_b32 v9, 0
    v_mov_b32 v8, 0
    v_mov_b32 v7, 0
    v_mov_b32 v6, 0
    v_mov_b32 v5, 0
    v_mov_b32 v4, 0
    v_mov_b32 v3, 0
    v_mov_b32 v2, 0
    v_mov_b32 v1, 0
    v_mov_b32 v0, 0
    v_max3_f32 v222, v112, v113, v114
    v_max3_f32 v222, v222, v115, v116
    v_max3_f32 v222, v222, v117, v118
    v_max_f32 v222, v222, v119
    v_max3_f32 v201, v120, v121, v122
    v_max3_f32 v201, v201, v123, v124
    v_max3_f32 v201, v201, v125, v126
    v_max_f32 v201, v201, v127
    v_mov_b32 v223, v222
    v_mov_b32 v202, v201
    s_nop 1
    v_permlane16_swap_b32 v222, v223
    v_permlane16_swap_b32 v201, v202
    s_nop 1
    v_max_f32 v222, v222, v223
    v_max_f32 v201, v201, v202
    v_mov_b32 v223, v222
    v_mov_b32 v202, v201
    s_nop 1
    v_permlane32_swap_b32 v222, v223
    v_permlane32_swap_b32 v201, v202
    s_nop 1
    v_max_f32 v222, v222, v223
    v_max_f32 v201, v201, v202
    v_add_f32 v222, 0x41800000, v222
    v_add_f32 v201, 0x41800000, v201
    v_sub_f32 v96, 0, v222
    v_sub_f32 v97, 0, v222
    v_sub_f32 v98, 0, v222
    v_sub_f32 v99, 0, v222
    v_sub_f32 v100, 0, v201
    v_sub_f32 v101, 0, v201
    v_sub_f32 v102, 0, v201
    v_sub_f32 v103, 0, v201
    v_sub_f32 v112, v112, v222
    v_sub_f32 v113, v113, v222
    v_sub_f32 v114, v114, v222
    v_sub_f32 v115, v115, v222
    v_sub_f32 v116, v116, v222
    v_sub_f32 v117, v117, v222
    v_sub_f32 v118, v118, v222
    v_sub_f32 v119, v119, v222
    v_sub_f32 v120, v120, v201
    v_sub_f32 v121, v121, v201
    v_sub_f32 v122, v122, v201
    v_sub_f32 v123, v123, v201
    v_sub_f32 v124, v124, v201
    v_sub_f32 v125, v125, v201
    v_sub_f32 v126, v126, v201
    v_sub_f32 v127, v127, v201
    v_exp_f32 v192, v112
    v_exp_f32 v193, v113
    s_waitcnt lgkmcnt(7)
    v_mfma_f32_16x16x32_bf16 v[128:131], v[160:163], v[64:67], v[96:99]
    v_exp_f32 v194, v114
    v_cvt_pk_bf16_f32 v144, v192, v193
    v_mfma_f32_16x16x32_bf16 v[136:139], v[160:163], v[80:83], v[100:103]
    v_exp_f32 v195, v115
    s_waitcnt lgkmcnt(6)
    v_mfma_f32_16x16x32_bf16 v[128:131], v[164:167], v[68:71], v[128:131]
    v_exp_f32 v196, v116
    v_cvt_pk_bf16_f32 v145, v194, v195
    v_mfma_f32_16x16x32_bf16 v[136:139], v[164:167], v[84:87], v[136:139]
    v_exp_f32 v197, v117
    s_waitcnt lgkmcnt(5)
    v_mfma_f32_16x16x32_bf16 v[128:131], v[168:171], v[72:75], v[128:131]
    v_exp_f32 v198, v118
    v_cvt_pk_bf16_f32 v146, v196, v197
    v_mfma_f32_16x16x32_bf16 v[136:139], v[168:171], v[88:91], v[136:139]
    v_exp_f32 v199, v119
    s_waitcnt lgkmcnt(4)
    v_mfma_f32_16x16x32_bf16 v[128:131], v[172:175], v[76:79], v[128:131]
    v_exp_f32 v192, v120
    v_cvt_pk_bf16_f32 v147, v198, v199
    v_mfma_f32_16x16x32_bf16 v[136:139], v[172:175], v[92:95], v[136:139]
    v_exp_f32 v193, v121
    s_waitcnt lgkmcnt(3)
    v_mfma_f32_16x16x32_bf16 v[132:135], v[176:179], v[64:67], v[96:99]
    v_exp_f32 v194, v122
    v_cvt_pk_bf16_f32 v148, v192, v193
    v_mfma_f32_16x16x32_bf16 v[140:143], v[176:179], v[80:83], v[100:103]
    v_exp_f32 v195, v123
    s_waitcnt lgkmcnt(2)
    v_mfma_f32_16x16x32_bf16 v[132:135], v[180:183], v[68:71], v[132:135]
    v_exp_f32 v196, v124
    v_cvt_pk_bf16_f32 v149, v194, v195
    v_mfma_f32_16x16x32_bf16 v[140:143], v[180:183], v[84:87], v[140:143]
    v_exp_f32 v197, v125
    s_waitcnt lgkmcnt(1)
    v_mfma_f32_16x16x32_bf16 v[132:135], v[184:187], v[72:75], v[132:135]
    v_exp_f32 v198, v126
    v_cvt_pk_bf16_f32 v150, v196, v197
    v_mfma_f32_16x16x32_bf16 v[140:143], v[184:187], v[88:91], v[140:143]
    v_exp_f32 v199, v127
    s_waitcnt lgkmcnt(0)
    v_mfma_f32_16x16x32_bf16 v[132:135], v[188:191], v[76:79], v[132:135]
    s_nop 0
    v_cvt_pk_bf16_f32 v151, v198, v199
    v_mfma_f32_16x16x32_bf16 v[140:143], v[188:191], v[92:95], v[140:143]
    s_mov_b32 s43, 0
    s_barrier
    ds_read_b128 v[160:163], v208 offset:32768
    ds_read_b128 v[164:167], v209 offset:32768
    ds_read_b128 v[168:171], v210 offset:32768
    ds_read_b64_tr_b16 v[172:173], v212 offset:49152
    ds_read_b64_tr_b16 v[174:175], v212 offset:53248
    ds_read_b128 v[176:179], v211 offset:32768
    ds_read_b64_tr_b16 v[180:181], v213 offset:49152
    ds_read_b64_tr_b16 v[182:183], v213 offset:53248
    ds_read_b128 v[184:187], v208 offset:36864
    v_exp_f32 v192, v128
    v_exp_f32 v193, v129
    s_branch L_mid
.p2align 3
L_top:
    v_mfma_f32_16x16x32_bf16 v[132:135], v[176:179], v[76:79], v[132:135]
    ds_read_b128 v[160:163], v208 offset:32768
    ds_read_b128 v[164:167], v209 offset:32768
    v_mfma_f32_16x16x32_bf16 v[140:143], v[176:179], v[92:95], v[140:143]
    v_exp_f32 v198, v126
    v_mfma_f32_16x16x32_bf16 v[20:23], v[180:183], v[152:155], v[20:23]
    ds_read_b128 v[168:171], v210 offset:32768
    ds_read_b64_tr_b16 v[172:173], v212 offset:49152
    ds_read_b64_tr_b16 v[174:175], v212 offset:53248
    v_cvt_pk_bf16_f32 v150, v196, v197
    v_mfma_f32_16x16x32_bf16 v[52:55], v[180:183], v[156:159], v[52:55]
    v_exp_f32 v199, v127
    v_mfma_f32_16x16x32_bf16 v[24:27], v[184:187], v[152:155], v[24:27]
    ds_read_b128 v[176:179], v211 offset:32768
    ds_read_b64_tr_b16 v[180:181], v213 offset:49152
    ds_read_b64_tr_b16 v[182:183], v213 offset:53248
    v_mfma_f32_16x16x32_bf16 v[56:59], v[184:187], v[156:159], v[56:59]
    v_exp_f32 v192, v128
    v_mfma_f32_16x16x32_bf16 v[108:111], v[204:207], v[156:159], v[108:111]
    v_cvt_pk_bf16_f32 v151, v198, v199
    v_or3_b32 v221, v221, v149, v150
    v_mfma_f32_16x16x32_bf16 v[28:31], v[188:191], v[152:155], v[28:31]
    ds_read_b128 v[184:187], v208 offset:36864
    v_bitop3_b32 v221, v221, v151, s46 bitop3:0xa8
    v_cmp_ne_u32 vcc, 0, v221
    v_mfma_f32_16x16x32_bf16 v[60:63], v[188:191], v[156:159], v[60:63]
    s_cbranch_vccnz L_tr2
L_bk2:
    v_exp_f32 v193, v129
L_mid:
    s_waitcnt lgkmcnt(7)
    v_mfma_f32_16x16x32_bf16 v[112:115], v[160:163], v[64:67], v[96:99]
    ds_read_b64_tr_b16 v[188:189], v214 offset:49152
    ds_read_b64_tr_b16 v[190:191], v214 offset:53248
    v_mfma_f32_16x16x32_bf16 v[120:123], v[160:163], v[80:83], v[100:103]
    v_exp_f32 v194, v130
    v_mfma_f32_16x16x32_bf16 v[112:115], v[164:167], v[68:71], v[112:115]
    ds_read_b128 v[160:163], v209 offset:36864
    v_cvt_pk_bf16_f32 v152, v192, v193
    v_mfma_f32_16x16x32_bf16 v[120:123], v[164:167], v[84:87], v[120:123]
    s_waitcnt lgkmcnt(6)
    v_exp_f32 v195, v131
    v_mfma_f32_16x16x32_bf16 v[112:115], v[168:171], v[72:75], v[112:115]
    ds_read_b64_tr_b16 v[164:165], v215 offset:49152
    ds_read_b64_tr_b16 v[166:167], v215 offset:53248
    v_mfma_f32_16x16x32_bf16 v[120:123], v[168:171], v[88:91], v[120:123]
    v_exp_f32 v196, v132
    v_mfma_f32_16x16x32_bf16 v[0:3], v[172:175], v[144:147], v[0:3]
    ds_read_b128 v[168:171], v210 offset:36864
    v_cvt_pk_bf16_f32 v153, v194, v195
    v_mfma_f32_16x16x32_bf16 v[32:35], v[172:175], v[148:151], v[32:35]
    v_exp_f32 v197, v133
    v_mfma_f32_16x16x32_bf16 v[112:115], v[176:179], v[76:79], v[112:115]
    ds_read_b64_tr_b16 v[172:173], v216 offset:49152
    ds_read_b64_tr_b16 v[174:175], v216 offset:53248
    v_mfma_f32_16x16x32_bf16 v[120:123], v[176:179], v[92:95], v[120:123]
    s_waitcnt lgkmcnt(5)
    v_exp_f32 v198, v134
    v_mfma_f32_16x16x32_bf16 v[4:7], v[180:183], v[144:147], v[4:7]
    ds_read_b128 v[176:179], v211 offset:36864
    v_cvt_pk_bf16_f32 v154, v196, v197
    v_mfma_f32_16x16x32_bf16 v[36:39], v[180:183], v[148:151], v[36:39]
    v_exp_f32 v199, v135
    v_mfma_f32_16x16x32_bf16 v[116:119], v[184:187], v[64:67], v[96:99]
    ds_read_b64_tr_b16 v[180:181], v217 offset:49152
    ds_read_b64_tr_b16 v[182:183], v217 offset:53248
    v_mfma_f32_16x16x32_bf16 v[124:127], v[184:187], v[80:83], v[100:103]
    v_exp_f32 v192, v136
    v_mfma_f32_16x16x32_bf16 v[8:11], v[188:191], v[144:147], v[8:11]
    ds_read_b64_tr_b16 v[184:185], v218 offset:49152
    ds_read_b64_tr_b16 v[186:187], v218 offset:53248
    v_mfma_f32_16x16x32_bf16 v[40:43], v[188:191], v[148:151], v[40:43]
    v_exp_f32 v193, v137
    v_mfma_f32_16x16x32_bf16 v[116:119], v[160:163], v[68:71], v[116:119]
    ds_read_b64_tr_b16 v[188:189], v219 offset:49152
    ds_read_b64_tr_b16 v[190:191], v219 offset:53248
    v_mfma_f32_16x16x32_bf16 v[124:127], v[160:163], v[84:87], v[124:127]
    s_waitcnt lgkmcnt(6)
    v_exp_f32 v194, v138
    v_mfma_f32_16x16x32_bf16 v[12:15], v[164:167], v[144:147], v[12:15]
    ds_read_b128 v[160:163], v208 offset:40960
    v_cvt_pk_bf16_f32 v155, v198, v199
    v_mfma_f32_16x16x32_bf16 v[44:47], v[164:167], v[148:151], v[44:47]
    v_exp_f32 v195, v139
    v_mfma_f32_16x16x32_bf16 v[116:119], v[168:171], v[72:75], v[116:119]
    ds_read_b128 v[164:167], v209 offset:40960
    v_cvt_pk_bf16_f32 v156, v192, v193
    v_mfma_f32_16x16x32_bf16 v[124:127], v[168:171], v[88:91], v[124:127]
    v_exp_f32 v196, v140
    v_mfma_f32_16x16x32_bf16 v[16:19], v[172:175], v[144:147], v[16:19]
    ds_read_b128 v[168:171], v210 offset:40960
    v_cvt_pk_bf16_f32 v157, v194, v195
    v_mfma_f32_16x16x32_bf16 v[48:51], v[172:175], v[148:151], v[48:51]
    v_exp_f32 v197, v141
    v_mfma_f32_16x16x32_bf16 v[104:107], v[204:207], v[144:147], v[104:107]
    v_or3_b32 v221, v152, v153, v154
    v_or3_b32 v221, v221, v155, v156
    v_mfma_f32_16x16x32_bf16 v[116:119], v[176:179], v[76:79], v[116:119]
    ds_read_b64_tr_b16 v[172:173], v212 offset:57344
    ds_read_b64_tr_b16 v[174:175], v212 offset:61440
    v_mfma_f32_16x16x32_bf16 v[124:127], v[176:179], v[92:95], v[124:127]
    s_waitcnt lgkmcnt(4)
    v_exp_f32 v198, v142
    v_mfma_f32_16x16x32_bf16 v[20:23], v[180:183], v[144:147], v[20:23]
    ds_read_b128 v[176:179], v211 offset:40960
    v_cvt_pk_bf16_f32 v158, v196, v197
    v_mfma_f32_16x16x32_bf16 v[52:55], v[180:183], v[148:151], v[52:55]
    v_exp_f32 v199, v143
    v_mfma_f32_16x16x32_bf16 v[24:27], v[184:187], v[144:147], v[24:27]
    ds_read_b64_tr_b16 v[180:181], v213 offset:57344
    ds_read_b64_tr_b16 v[182:183], v213 offset:61440
    v_mfma_f32_16x16x32_bf16 v[56:59], v[184:187], v[148:151], v[56:59]
    v_exp_f32 v192, v112
    v_mfma_f32_16x16x32_bf16 v[108:111], v[204:207], v[148:151], v[108:111]
    v_cvt_pk_bf16_f32 v159, v198, v199
    v_or3_b32 v221, v221, v157, v158
    v_mfma_f32_16x16x32_bf16 v[28:31], v[188:191], v[144:147], v[28:31]
    ds_read_b128 v[184:187], v208 offset:45056
    v_bitop3_b32 v221, v221, v159, s46 bitop3:0xa8
    v_cmp_ne_u32 vcc, 0, v221
    v_mfma_f32_16x16x32_bf16 v[60:63], v[188:191], v[148:151], v[60:63]
    s_cbranch_vccnz L_tr3
L_bk3:
    v_exp_f32 v193, v113
    v_mfma_f32_16x16x32_bf16 v[128:131], v[160:163], v[64:67], v[96:99]
    ds_read_b64_tr_b16 v[188:189], v214 offset:57344
    ds_read_b64_tr_b16 v[190:191], v214 offset:61440
    v_mfma_f32_16x16x32_bf16 v[136:139], v[160:163], v[80:83], v[100:103]
    s_waitcnt lgkmcnt(5)
    v_exp_f32 v194, v114
    v_mfma_f32_16x16x32_bf16 v[128:131], v[164:167], v[68:71], v[128:131]
    ds_read_b128 v[160:163], v209 offset:45056
    v_cvt_pk_bf16_f32 v144, v192, v193
    v_add_u32 v212, 0x10000, v212
    v_mfma_f32_16x16x32_bf16 v[136:139], v[164:167], v[84:87], v[136:139]
    v_exp_f32 v195, v115
    v_mfma_f32_16x16x32_bf16 v[128:131], v[168:171], v[72:75], v[128:131]
    ds_read_b64_tr_b16 v[164:165], v215 offset:57344
    ds_read_b64_tr_b16 v[166:167], v215 offset:61440
    v_mfma_f32_16x16x32_bf16 v[136:139], v[168:171], v[88:91], v[136:139]
    v_exp_f32 v196, v116
    v_mfma_f32_16x16x32_bf16 v[0:3], v[172:175], v[152:155], v[0:3]
    ds_read_b128 v[168:171], v210 offset:45056
    v_cvt_pk_bf16_f32 v145, v194, v195
    v_add_u32 v213, 0x10000, v213
    v_mfma_f32_16x16x32_bf16 v[32:35], v[172:175], v[156:159], v[32:35]
    v_exp_f32 v197, v117
    v_mfma_f32_16x16x32_bf16 v[128:131], v[176:179], v[76:79], v[128:131]
    ds_read_b64_tr_b16 v[172:173], v216 offset:57344
    ds_read_b64_tr_b16 v[174:175], v216 offset:61440
    v_mfma_f32_16x16x32_bf16 v[136:139], v[176:179], v[92:95], v[136:139]
    s_waitcnt lgkmcnt(5)
    v_exp_f32 v198, v118
    v_mfma_f32_16x16x32_bf16 v[4:7], v[180:183], v[152:155], v[4:7]
    ds_read_b128 v[176:179], v211 offset:45056
    v_cvt_pk_bf16_f32 v146, v196, v197
    v_add_u32 v214, 0x10000, v214
    v_mfma_f32_16x16x32_bf16 v[36:39], v[180:183], v[156:159], v[36:39]
    v_exp_f32 v199, v119
    v_mfma_f32_16x16x32_bf16 v[132:135], v[184:187], v[64:67], v[96:99]
    ds_read_b64_tr_b16 v[180:181], v217 offset:57344
    ds_read_b64_tr_b16 v[182:183], v217 offset:61440
    v_mfma_f32_16x16x32_bf16 v[140:143], v[184:187], v[80:83], v[100:103]
    v_exp_f32 v192, v120
    v_mfma_f32_16x16x32_bf16 v[8:11], v[188:191], v[152:155], v[8:11]
    ds_read_b64_tr_b16 v[184:185], v218 offset:57344
    ds_read_b64_tr_b16 v[186:187], v218 offset:61440
    v_mfma_f32_16x16x32_bf16 v[40:43], v[188:191], v[156:159], v[40:43]
    v_exp_f32 v193, v121
    v_mfma_f32_16x16x32_bf16 v[132:135], v[160:163], v[68:71], v[132:135]
    ds_read_b64_tr_b16 v[188:189], v219 offset:57344
    ds_read_b64_tr_b16 v[190:191], v219 offset:61440
    v_mfma_f32_16x16x32_bf16 v[140:143], v[160:163], v[84:87], v[140:143]
    s_waitcnt lgkmcnt(7)
    v_exp_f32 v194, v122
    v_mfma_f32_16x16x32_bf16 v[12:15], v[164:167], v[152:155], v[12:15]
    v_cvt_pk_bf16_f32 v147, v198, v199
    v_add_u32 v208, 0x10000, v208
    v_add_u32 v209, 0x10000, v209
    v_add_u32 v210, 0x10000, v210
    v_mfma_f32_16x16x32_bf16 v[44:47], v[164:167], v[156:159], v[44:47]
    v_exp_f32 v195, v123
    v_mfma_f32_16x16x32_bf16 v[132:135], v[168:171], v[72:75], v[132:135]
    v_cvt_pk_bf16_f32 v148, v192, v193
    v_add_u32 v211, 0x10000, v211
    v_add_u32 v215, 0x10000, v215
    v_add_u32 v216, 0x10000, v216
    v_mfma_f32_16x16x32_bf16 v[140:143], v[168:171], v[88:91], v[140:143]
    v_exp_f32 v196, v124
    v_mfma_f32_16x16x32_bf16 v[16:19], v[172:175], v[152:155], v[16:19]
    v_cvt_pk_bf16_f32 v149, v194, v195
    v_add_u32 v217, 0x10000, v217
    v_add_u32 v218, 0x10000, v218
    v_add_u32 v219, 0x10000, v219
    v_mfma_f32_16x16x32_bf16 v[48:51], v[172:175], v[156:159], v[48:51]
    s_waitcnt lgkmcnt(0)
    v_exp_f32 v197, v125
    v_mfma_f32_16x16x32_bf16 v[104:107], v[204:207], v[152:155], v[104:107]
    v_or3_b32 v221, v144, v145, v146
    v_or3_b32 v221, v221, v147, v148
    s_barrier
    v_mfma_f32_16x16x32_bf16 v[132:135], v[176:179], v[76:79], v[132:135]
    ds_read_b128 v[160:163], v208 offset:0
    ds_read_b128 v[164:167], v209 offset:0
    v_mfma_f32_16x16x32_bf16 v[140:143], v[176:179], v[92:95], v[140:143]
    v_exp_f32 v198, v126
    v_mfma_f32_16x16x32_bf16 v[20:23], v[180:183], v[152:155], v[20:23]
    ds_read_b128 v[168:171], v210 offset:0
    ds_read_b64_tr_b16 v[172:173], v212 offset:16384
    ds_read_b64_tr_b16 v[174:175], v212 offset:20480
    v_cvt_pk_bf16_f32 v150, v196, v197
    v_mfma_f32_16x16x32_bf16 v[52:55], v[180:183], v[156:159], v[52:55]
    v_exp_f32 v199, v127
    v_mfma_f32_16x16x32_bf16 v[24:27], v[184:187], v[152:155], v[24:27]
    ds_read_b128 v[176:179], v211 offset:0
    ds_read_b64_tr_b16 v[180:181], v213 offset:16384
    ds_read_b64_tr_b16 v[182:183], v213 offset:20480
    v_mfma_f32_16x16x32_bf16 v[56:59], v[184:187], v[156:159], v[56:59]
    v_exp_f32 v192, v128
    v_mfma_f32_16x16x32_bf16 v[108:111], v[204:207], v[156:159], v[108:111]
    v_cvt_pk_bf16_f32 v151, v198, v199
    v_or3_b32 v221, v221, v149, v150
    v_mfma_f32_16x16x32_bf16 v[28:31], v[188:191], v[152:155], v[28:31]
    ds_read_b128 v[184:187], v208 offset:4096
    v_bitop3_b32 v221, v221, v151, s46 bitop3:0xa8
    v_cmp_ne_u32 vcc, 0, v221
    v_mfma_f32_16x16x32_bf16 v[60:63], v[188:191], v[156:159], v[60:63]
    s_cbranch_vccnz L_tr4
L_bk4:
    v_exp_f32 v193, v129
    s_waitcnt lgkmcnt(7)
    v_mfma_f32_16x16x32_bf16 v[112:115], v[160:163], v[64:67], v[96:99]
    ds_read_b64_tr_b16 v[188:189], v214 offset:16384
    ds_read_b64_tr_b16 v[190:191], v214 offset:20480
    v_mfma_f32_16x16x32_bf16 v[120:123], v[160:163], v[80:83], v[100:103]
    v_exp_f32 v194, v130
    v_mfma_f32_16x16x32_bf16 v[112:115], v[164:167], v[68:71], v[112:115]
    ds_read_b128 v[160:163], v209 offset:4096
    v_cvt_pk_bf16_f32 v152, v192, v193
    v_mfma_f32_16x16x32_bf16 v[120:123], v[164:167], v[84:87], v[120:123]
    s_waitcnt lgkmcnt(6)
    v_exp_f32 v195, v131
    v_mfma_f32_16x16x32_bf16 v[112:115], v[168:171], v[72:75], v[112:115]
    ds_read_b64_tr_b16 v[164:165], v215 offset:16384
    ds_read_b64_tr_b16 v[166:167], v215 offset:20480
    v_mfma_f32_16x16x32_bf16 v[120:123], v[168:171], v[88:91], v[120:123]
    v_exp_f32 v196, v132
    v_mfma_f32_16x16x32_bf16 v[0:3], v[172:175], v[144:147], v[0:3]
    ds_read_b128 v[168:171], v210 offset:4096
    v_cvt_pk_bf16_f32 v153, v194, v195
    v_mfma_f32_16x16x32_bf16 v[32:35], v[172:175], v[148:151], v[32:35]
    v_exp_f32 v197, v133
    v_mfma_f32_16x16x32_bf16 v[112:115], v[176:179], v[76:79], v[112:115]
    ds_read_b64_tr_b16 v[172:173], v216 offset:16384
    ds_read_b64_tr_b16 v[174:175], v216 offset:20480
    v_mfma_f32_16x16x32_bf16 v[120:123], v[176:179], v[92:95], v[120:123]
    s_waitcnt lgkmcnt(5)
    v_exp_f32 v198, v134
    v_mfma_f32_16x16x32_bf16 v[4:7], v[180:183], v[144:147], v[4:7]
    ds_read_b128 v[176:179], v211 offset:4096
    v_cvt_pk_bf16_f32 v154, v196, v197
    v_mfma_f32_16x16x32_bf16 v[36:39], v[180:183], v[148:151], v[36:39]
    v_exp_f32 v199, v135
    v_mfma_f32_16x16x32_bf16 v[116:119], v[184:187], v[64:67], v[96:99]
    ds_read_b64_tr_b16 v[180:181], v217 offset:16384
    ds_read_b64_tr_b16 v[182:183], v217 offset:20480
    v_mfma_f32_16x16x32_bf16 v[124:127], v[184:187], v[80:83], v[100:103]
    v_exp_f32 v192, v136
    v_mfma_f32_16x16x32_bf16 v[8:11], v[188:191], v[144:147], v[8:11]
    ds_read_b64_tr_b16 v[184:185], v218 offset:16384
    ds_read_b64_tr_b16 v[186:187], v218 offset:20480
    v_mfma_f32_16x16x32_bf16 v[40:43], v[188:191], v[148:151], v[40:43]
    v_exp_f32 v193, v137
    v_mfma_f32_16x16x32_bf16 v[116:119], v[160:163], v[68:71], v[116:119]
    ds_read_b64_tr_b16 v[188:189], v219 offset:16384
    ds_read_b64_tr_b16 v[190:191], v219 offset:20480
    v_mfma_f32_16x16x32_bf16 v[124:127], v[160:163], v[84:87], v[124:127]
    s_waitcnt lgkmcnt(6)
    v_exp_f32 v194, v138
    v_mfma_f32_16x16x32_bf16 v[12:15], v[164:167], v[144:147], v[12:15]
    ds_read_b128 v[160:163], v208 offset:8192
    v_cvt_pk_bf16_f32 v155, v198, v199
    v_mfma_f32_16x16x32_bf16 v[44:47], v[164:167], v[148:151], v[44:47]
    v_exp_f32 v195, v139
    v_mfma_f32_16x16x32_bf16 v[116:119], v[168:171], v[72:75], v[116:119]
    ds_read_b128 v[164:167], v209 offset:8192
    v_cvt_pk_bf16_f32 v156, v192, v193
    v_mfma_f32_16x16x32_bf16 v[124:127], v[168:171], v[88:91], v[124:127]
    v_exp_f32 v196, v140
    v_mfma_f32_16x16x32_bf16 v[16:19], v[172:175], v[144:147], v[16:19]
    ds_read_b128 v[168:171], v210 offset:8192
    v_cvt_pk_bf16_f32 v157, v194, v195
    v_mfma_f32_16x16x32_bf16 v[48:51], v[172:175], v[148:151], v[48:51]
    v_exp_f32 v197, v141
    v_mfma_f32_16x16x32_bf16 v[104:107], v[204:207], v[144:147], v[104:107]
    v_or3_b32 v221, v152, v153, v154
    v_or3_b32 v221, v221, v155, v156
    v_mfma_f32_16x16x32_bf16 v[116:119], v[176:179], v[76:79], v[116:119]
    ds_read_b64_tr_b16 v[172:173], v212 offset:24576
    ds_read_b64_tr_b16 v[174:175], v212 offset:28672
    v_mfma_f32_16x16x32_bf16 v[124:127], v[176:179], v[92:95], v[124:127]
    s_waitcnt lgkmcnt(4)
    v_exp_f32 v198, v142
    v_mfma_f32_16x16x32_bf16 v[20:23], v[180:183], v[144:147], v[20:23]
    ds_read_b128 v[176:179], v211 offset:8192
    v_cvt_pk_bf16_f32 v158, v196, v197
    v_mfma_f32_16x16x32_bf16 v[52:55], v[180:183], v[148:151], v[52:55]
    v_exp_f32 v199, v143
    v_mfma_f32_16x16x32_bf16 v[24:27], v[184:187], v[144:147], v[24:27]
    ds_read_b64_tr_b16 v[180:181], v213 offset:24576
    ds_read_b64_tr_b16 v[182:183], v213 offset:28672
    v_mfma_f32_16x16x32_bf16 v[56:59], v[184:187], v[148:151], v[56:59]
    v_exp_f32 v192, v112
    v_mfma_f32_16x16x32_bf16 v[108:111], v[204:207], v[148:151], v[108:111]
    v_cvt_pk_bf16_f32 v159, v198, v199
    v_or3_b32 v221, v221, v157, v158
    v_mfma_f32_16x16x32_bf16 v[28:31], v[188:191], v[144:147], v[28:31]
    ds_read_b128 v[184:187], v208 offset:12288
    v_bitop3_b32 v221, v221, v159, s46 bitop3:0xa8
    v_cmp_ne_u32 vcc, 0, v221
    v_mfma_f32_16x16x32_bf16 v[60:63], v[188:191], v[148:151], v[60:63]
    s_cbranch_vccnz L_tr5
L_bk5:
    v_exp_f32 v193, v113
    v_mfma_f32_16x16x32_bf16 v[128:131], v[160:163], v[64:67], v[96:99]
    ds_read_b64_tr_b16 v[188:189], v214 offset:24576
    ds_read_b64_tr_b16 v[190:191], v214 offset:28672
    v_mfma_f32_16x16x32_bf16 v[136:139], v[160:163], v[80:83], v[100:103]
    s_waitcnt lgkmcnt(5)
    v_exp_f32 v194, v114
    v_mfma_f32_16x16x32_bf16 v[128:131], v[164:167], v[68:71], v[128:131]
    ds_read_b128 v[160:163], v209 offset:12288
    v_cvt_pk_bf16_f32 v144, v192, v193
    v_add_u32 v212, 0xffff0000, v212
    v_mfma_f32_16x16x32_bf16 v[136:139], v[164:167], v[84:87], v[136:139]
    v_exp_f32 v195, v115
    v_mfma_f32_16x16x32_bf16 v[128:131], v[168:171], v[72:75], v[128:131]
    ds_read_b64_tr_b16 v[164:165], v215 offset:24576
    ds_read_b64_tr_b16 v[166:167], v215 offset:28672
    v_mfma_f32_16x16x32_bf16 v[136:139], v[168:171], v[88:91], v[136:139]
    v_exp_f32 v196, v116
    v_mfma_f32_16x16x32_bf16 v[0:3], v[172:175], v[152:155], v[0:3]
    ds_read_b128 v[168:171], v210 offset:12288
    v_cvt_pk_bf16_f32 v145, v194, v195
    v_add_u32 v213, 0xffff0000, v213
    v_mfma_f32_16x16x32_bf16 v[32:35], v[172:175], v[156:159], v[32:35]
    v_exp_f32 v197, v117
    v_mfma_f32_16x16x32_bf16 v[128:131], v[176:179], v[76:79], v[128:131]
    ds_read_b64_tr_b16 v[172:173], v216 offset:24576
    ds_read_b64_tr_b16 v[174:175], v216 offset:28672
    v_mfma_f32_16x16x32_bf16 v[136:139], v[176:179], v[92:95], v[136:139]
    s_waitcnt lgkmcnt(5)
    v_exp_f32 v198, v118
    v_mfma_f32_16x16x32_bf16 v[4:7], v[180:183], v[152:155], v[4:7]
    ds_read_b128 v[176:179], v211 offset:12288
    v_cvt_pk_bf16_f32 v146, v196, v197
    v_add_u32 v214, 0xffff0000, v214
    v_mfma_f32_16x16x32_bf16 v[36:39], v[180:183], v[156:159], v[36:39]
    v_exp_f32 v199, v119
    v_mfma_f32_16x16x32_bf16 v[132:135], v[184:187], v[64:67], v[96:99]
    ds_read_b64_tr_b16 v[180:181], v217 offset:24576
    ds_read_b64_tr_b16 v[182:183], v217 offset:28672
    v_mfma_f32_16x16x32_bf16 v[140:143], v[184:187], v[80:83], v[100:103]
    v_exp_f32 v192, v120
    v_mfma_f32_16x16x32_bf16 v[8:11], v[188:191], v[152:155], v[8:11]
    ds_read_b64_tr_b16 v[184:185], v218 offset:24576
    ds_read_b64_tr_b16 v[186:187], v218 offset:28672
    v_mfma_f32_16x16x32_bf16 v[40:43], v[188:191], v[156:159], v[40:43]
    v_exp_f32 v193, v121
    v_mfma_f32_16x16x32_bf16 v[132:135], v[160:163], v[68:71], v[132:135]
    ds_read_b64_tr_b16 v[188:189], v219 offset:24576
    ds_read_b64_tr_b16 v[190:191], v219 offset:28672
    v_mfma_f32_16x16x32_bf16 v[140:143], v[160:163], v[84:87], v[140:143]
    s_waitcnt lgkmcnt(7)
    v_exp_f32 v194, v122
    v_mfma_f32_16x16x32_bf16 v[12:15], v[164:167], v[152:155], v[12:15]
    v_cvt_pk_bf16_f32 v147, v198, v199
    v_add_u32 v208, 0xffff0000, v208
    v_add_u32 v209, 0xffff0000, v209
    v_add_u32 v210, 0xffff0000, v210
    v_mfma_f32_16x16x32_bf16 v[44:47], v[164:167], v[156:159], v[44:47]
    v_exp_f32 v195, v123
    v_mfma_f32_16x16x32_bf16 v[132:135], v[168:171], v[72:75], v[132:135]
    v_cvt_pk_bf16_f32 v148, v192, v193
    v_add_u32 v211, 0xffff0000, v211
    v_add_u32 v215, 0xffff0000, v215
    v_add_u32 v216, 0xffff0000, v216
    v_mfma_f32_16x16x32_bf16 v[140:143], v[168:171], v[88:91], v[140:143]
    v_exp_f32 v196, v124
    v_mfma_f32_16x16x32_bf16 v[16:19], v[172:175], v[152:155], v[16:19]
    v_cvt_pk_bf16_f32 v149, v194, v195
    v_add_u32 v217, 0xffff0000, v217
    v_add_u32 v218, 0xffff0000, v218
    v_add_u32 v219, 0xffff0000, v219
    v_mfma_f32_16x16x32_bf16 v[48:51], v[172:175], v[156:159], v[48:51]
    s_waitcnt lgkmcnt(0)
    v_exp_f32 v197, v125
    v_mfma_f32_16x16x32_bf16 v[104:107], v[204:207], v[152:155], v[104:107]
    v_or3_b32 v221, v144, v145, v146
    v_or3_b32 v221, v221, v147, v148
    s_barrier
    v_mfma_f32_16x16x32_bf16 v[132:135], v[176:179], v[76:79], v[132:135]
    ds_read_b128 v[160:163], v208 offset:0
    ds_read_b128 v[164:167], v209 offset:0
    v_mfma_f32_16x16x32_bf16 v[140:143], v[176:179], v[92:95], v[140:143]
    v_exp_f32 v198, v126
    v_mfma_f32_16x16x32_bf16 v[20:23], v[180:183], v[152:155], v[20:23]
    ds_read_b128 v[168:171], v210 offset:0
    ds_read_b64_tr_b16 v[172:173], v212 offset:16384
    ds_read_b64_tr_b16 v[174:175], v212 offset:20480
    v_cvt_pk_bf16_f32 v150, v196, v197
    v_mfma_f32_16x16x32_bf16 v[52:55], v[180:183], v[156:159], v[52:55]
    v_exp_f32 v199, v127
    v_mfma_f32_16x16x32_bf16 v[24:27], v[184:187], v[152:155], v[24:27]
    ds_read_b128 v[176:179], v211 offset:0
    ds_read_b64_tr_b16 v[180:181], v213 offset:16384
    ds_read_b64_tr_b16 v[182:183], v213 offset:20480
    v_mfma_f32_16x16x32_bf16 v[56:59], v[184:187], v[156:159], v[56:59]
    v_exp_f32 v192, v128
    v_mfma_f32_16x16x32_bf16 v[108:111], v[204:207], v[156:159], v[108:111]
    v_cvt_pk_bf16_f32 v151, v198, v199
    v_or3_b32 v221, v221, v149, v150
    v_mfma_f32_16x16x32_bf16 v[28:31], v[188:191], v[152:155], v[28:31]
    ds_read_b128 v[184:187], v208 offset:4096
    v_bitop3_b32 v221, v221, v151, s46 bitop3:0xa8
    v_cmp_ne_u32 vcc, 0, v221
    v_mfma_f32_16x16x32_bf16 v[60:63], v[188:191], v[156:159], v[60:63]
    s_cbranch_vccnz L_tr6
L_bk6:
    v_exp_f32 v193, v129
    s_waitcnt lgkmcnt(7)
    v_mfma_f32_16x16x32_bf16 v[112:115], v[160:163], v[64:67], v[96:99]
    ds_read_b64_tr_b16 v[188:189], v214 offset:16384
    ds_read_b64_tr_b16 v[190:191], v214 offset:20480
    v_mfma_f32_16x16x32_bf16 v[120:123], v[160:163], v[80:83], v[100:103]
    v_exp_f32 v194, v130
    v_mfma_f32_16x16x32_bf16 v[112:115], v[164:167], v[68:71], v[112:115]
    ds_read_b128 v[160:163], v209 offset:4096
    v_cvt_pk_bf16_f32 v152, v192, v193
    v_mfma_f32_16x16x32_bf16 v[120:123], v[164:167], v[84:87], v[120:123]
    s_waitcnt lgkmcnt(6)
    v_exp_f32 v195, v131
    v_mfma_f32_16x16x32_bf16 v[112:115], v[168:171], v[72:75], v[112:115]
    ds_read_b64_tr_b16 v[164:165], v215 offset:16384
    ds_read_b64_tr_b16 v[166:167], v215 offset:20480
    v_mfma_f32_16x16x32_bf16 v[120:123], v[168:171], v[88:91], v[120:123]
    v_exp_f32 v196, v132
    v_mfma_f32_16x16x32_bf16 v[0:3], v[172:175], v[144:147], v[0:3]
    ds_read_b128 v[168:171], v210 offset:4096
    v_cvt_pk_bf16_f32 v153, v194, v195
    v_mfma_f32_16x16x32_bf16 v[32:35], v[172:175], v[148:151], v[32:35]
    v_exp_f32 v197, v133
    v_mfma_f32_16x16x32_bf16 v[112:115], v[176:179], v[76:79], v[112:115]
    ds_read_b64_tr_b16 v[172:173], v216 offset:16384
    ds_read_b64_tr_b16 v[174:175], v216 offset:20480
    v_mfma_f32_16x16x32_bf16 v[120:123], v[176:179], v[92:95], v[120:123]
    s_waitcnt lgkmcnt(5)
    v_exp_f32 v198, v134
    v_mfma_f32_16x16x32_bf16 v[4:7], v[180:183], v[144:147], v[4:7]
    ds_read_b128 v[176:179], v211 offset:4096
    v_cvt_pk_bf16_f32 v154, v196, v197
    v_mfma_f32_16x16x32_bf16 v[36:39], v[180:183], v[148:151], v[36:39]
    v_exp_f32 v199, v135
    v_mfma_f32_16x16x32_bf16 v[116:119], v[184:187], v[64:67], v[96:99]
    ds_read_b64_tr_b16 v[180:181], v217 offset:16384
    ds_read_b64_tr_b16 v[182:183], v217 offset:20480
    v_mfma_f32_16x16x32_bf16 v[124:127], v[184:187], v[80:83], v[100:103]
    v_exp_f32 v192, v136
    v_mfma_f32_16x16x32_bf16 v[8:11], v[188:191], v[144:147], v[8:11]
    ds_read_b64_tr_b16 v[184:185], v218 offset:16384
    ds_read_b64_tr_b16 v[186:187], v218 offset:20480
    v_mfma_f32_16x16x32_bf16 v[40:43], v[188:191], v[148:151], v[40:43]
    v_exp_f32 v193, v137
    v_mfma_f32_16x16x32_bf16 v[116:119], v[160:163], v[68:71], v[116:119]
    ds_read_b64_tr_b16 v[188:189], v219 offset:16384
    ds_read_b64_tr_b16 v[190:191], v219 offset:20480
    v_mfma_f32_16x16x32_bf16 v[124:127], v[160:163], v[84:87], v[124:127]
    s_waitcnt lgkmcnt(6)
    v_exp_f32 v194, v138
    v_mfma_f32_16x16x32_bf16 v[12:15], v[164:167], v[144:147], v[12:15]
    ds_read_b128 v[160:163], v208 offset:8192
    v_cvt_pk_bf16_f32 v155, v198, v199
    v_mfma_f32_16x16x32_bf16 v[44:47], v[164:167], v[148:151], v[44:47]
    v_exp_f32 v195, v139
    v_mfma_f32_16x16x32_bf16 v[116:119], v[168:171], v[72:75], v[116:119]
    ds_read_b128 v[164:167], v209 offset:8192
    v_cvt_pk_bf16_f32 v156, v192, v193
    v_mfma_f32_16x16x32_bf16 v[124:127], v[168:171], v[88:91], v[124:127]
    v_exp_f32 v196, v140
    v_mfma_f32_16x16x32_bf16 v[16:19], v[172:175], v[144:147], v[16:19]
    ds_read_b128 v[168:171], v210 offset:8192
    v_cvt_pk_bf16_f32 v157, v194, v195
    v_mfma_f32_16x16x32_bf16 v[48:51], v[172:175], v[148:151], v[48:51]
    v_exp_f32 v197, v141
    v_mfma_f32_16x16x32_bf16 v[104:107], v[204:207], v[144:147], v[104:107]
    v_or3_b32 v221, v152, v153, v154
    v_or3_b32 v221, v221, v155, v156
    v_mfma_f32_16x16x32_bf16 v[116:119], v[176:179], v[76:79], v[116:119]
    ds_read_b64_tr_b16 v[172:173], v212 offset:24576
    ds_read_b64_tr_b16 v[174:175], v212 offset:28672
    v_mfma_f32_16x16x32_bf16 v[124:127], v[176:179], v[92:95], v[124:127]
    s_waitcnt lgkmcnt(4)
    v_exp_f32 v198, v142
    v_mfma_f32_16x16x32_bf16 v[20:23], v[180:183], v[144:147], v[20:23]
    ds_read_b128 v[176:179], v211 offset:8192
    v_cvt_pk_bf16_f32 v158, v196, v197
    v_mfma_f32_16x16x32_bf16 v[52:55], v[180:183], v[148:151], v[52:55]
    v_exp_f32 v199, v143
    v_mfma_f32_16x16x32_bf16 v[24:27], v[184:187], v[144:147], v[24:27]
    ds_read_b64_tr_b16 v[180:181], v213 offset:24576
    ds_read_b64_tr_b16 v[182:183], v213 offset:28672
    v_mfma_f32_16x16x32_bf16 v[56:59], v[184:187], v[148:151], v[56:59]
    v_exp_f32 v192, v112
    v_mfma_f32_16x16x32_bf16 v[108:111], v[204:207], v[148:151], v[108:111]
    v_cvt_pk_bf16_f32 v159, v198, v199
    v_or3_b32 v221, v221, v157, v158
    v_mfma_f32_16x16x32_bf16 v[28:31], v[188:191], v[144:147], v[28:31]
    ds_read_b128 v[184:187], v208 offset:12288
    v_bitop3_b32 v221, v221, v159, s46 bitop3:0xa8
    v_cmp_ne_u32 vcc, 0, v221
    v_mfma_f32_16x16x32_bf16 v[60:63], v[188:191], v[148:151], v[60:63]
    s_cbranch_vccnz L_tr7
L_bk7:
    v_exp_f32 v193, v113
    v_mfma_f32_16x16x32_bf16 v[128:131], v[160:163], v[64:67], v[96:99]
    ds_read_b64_tr_b16 v[188:189], v214 offset:24576
    ds_read_b64_tr_b16 v[190:191], v214 offset:28672
    v_mfma_f32_16x16x32_bf16 v[136:139], v[160:163], v[80:83], v[100:103]
    s_waitcnt lgkmcnt(5)
    v_exp_f32 v194, v114
    v_mfma_f32_16x16x32_bf16 v[128:131], v[164:167], v[68:71], v[128:131]
    ds_read_b128 v[160:163], v209 offset:12288
    v_cvt_pk_bf16_f32 v144, v192, v193
    v_mfma_f32_16x16x32_bf16 v[136:139], v[164:167], v[84:87], v[136:139]
    v_exp_f32 v195, v115
    v_mfma_f32_16x16x32_bf16 v[128:131], v[168:171], v[72:75], v[128:131]
    ds_read_b64_tr_b16 v[164:165], v215 offset:24576
    ds_read_b64_tr_b16 v[166:167], v215 offset:28672
    v_mfma_f32_16x16x32_bf16 v[136:139], v[168:171], v[88:91], v[136:139]
    v_exp_f32 v196, v116
    v_mfma_f32_16x16x32_bf16 v[0:3], v[172:175], v[152:155], v[0:3]
    ds_read_b128 v[168:171], v210 offset:12288
    v_cvt_pk_bf16_f32 v145, v194, v195
    v_mfma_f32_16x16x32_bf16 v[32:35], v[172:175], v[156:159], v[32:35]
    v_exp_f32 v197, v117
    v_mfma_f32_16x16x32_bf16 v[128:131], v[176:179], v[76:79], v[128:131]
    ds_read_b64_tr_b16 v[172:173], v216 offset:24576
    ds_read_b64_tr_b16 v[174:175], v216 offset:28672
    v_mfma_f32_16x16x32_bf16 v[136:139], v[176:179], v[92:95], v[136:139]
    s_waitcnt lgkmcnt(5)
    v_exp_f32 v198, v118
    v_mfma_f32_16x16x32_bf16 v[4:7], v[180:183], v[152:155], v[4:7]
    ds_read_b128 v[176:179], v211 offset:12288
    v_cvt_pk_bf16_f32 v146, v196, v197
    v_mfma_f32_16x16x32_bf16 v[36:39], v[180:183], v[156:159], v[36:39]
    v_exp_f32 v199, v119
    v_mfma_f32_16x16x32_bf16 v[132:135], v[184:187], v[64:67], v[96:99]
    ds_read_b64_tr_b16 v[180:181], v217 offset:24576
    ds_read_b64_tr_b16 v[182:183], v217 offset:28672
    v_mfma_f32_16x16x32_bf16 v[140:143], v[184:187], v[80:83], v[100:103]
    v_exp_f32 v192, v120
    v_mfma_f32_16x16x32_bf16 v[8:11], v[188:191], v[152:155], v[8:11]
    ds_read_b64_tr_b16 v[184:185], v218 offset:24576
    ds_read_b64_tr_b16 v[186:187], v218 offset:28672
    v_mfma_f32_16x16x32_bf16 v[40:43], v[188:191], v[156:159], v[40:43]
    v_exp_f32 v193, v121
    v_mfma_f32_16x16x32_bf16 v[132:135], v[160:163], v[68:71], v[132:135]
    ds_read_b64_tr_b16 v[188:189], v219 offset:24576
    ds_read_b64_tr_b16 v[190:191], v219 offset:28672
    v_mfma_f32_16x16x32_bf16 v[140:143], v[160:163], v[84:87], v[140:143]
    s_waitcnt lgkmcnt(7)
    v_exp_f32 v194, v122
    v_mfma_f32_16x16x32_bf16 v[12:15], v[164:167], v[152:155], v[12:15]
    v_cvt_pk_bf16_f32 v147, v198, v199
    s_add_u32 s43, s43, 1
    s_cmp_lt_u32 s43, 5
    v_mfma_f32_16x16x32_bf16 v[44:47], v[164:167], v[156:159], v[44:47]
    v_exp_f32 v195, v123
    v_mfma_f32_16x16x32_bf16 v[132:135], v[168:171], v[72:75], v[132:135]
    v_cvt_pk_bf16_f32 v148, v192, v193
    v_mfma_f32_16x16x32_bf16 v[140:143], v[168:171], v[88:91], v[140:143]
    v_exp_f32 v196, v124
    v_mfma_f32_16x16x32_bf16 v[16:19], v[172:175], v[152:155], v[16:19]
    v_cvt_pk_bf16_f32 v149, v194, v195
    v_mfma_f32_16x16x32_bf16 v[48:51], v[172:175], v[156:159], v[48:51]
    s_waitcnt lgkmcnt(0)
    v_exp_f32 v197, v125
    v_mfma_f32_16x16x32_bf16 v[104:107], v[204:207], v[152:155], v[104:107]
    v_or3_b32 v221, v144, v145, v146
    v_or3_b32 v221, v221, v147, v148
    s_barrier
    s_cbranch_scc1 L_top
    v_mfma_f32_16x16x32_bf16 v[132:135], v[176:179], v[76:79], v[132:135]
    ds_read_b64_tr_b16 v[160:161], v212 offset:49152
    ds_read_b64_tr_b16 v[162:163], v212 offset:53248
    ds_read_b64_tr_b16 v[164:165], v212 offset:57344
    ds_read_b64_tr_b16 v[166:167], v212 offset:61440
    v_mfma_f32_16x16x32_bf16 v[140:143], v[176:179], v[92:95], v[140:143]
    v_exp_f32 v198, v126
    v_mfma_f32_16x16x32_bf16 v[20:23], v[180:183], v[152:155], v[20:23]
    ds_read_b64_tr_b16 v[168:169], v213 offset:49152
    ds_read_b64_tr_b16 v[170:171], v213 offset:53248
    ds_read_b64_tr_b16 v[172:173], v213 offset:57344
    ds_read_b64_tr_b16 v[174:175], v213 offset:61440
    v_cvt_pk_bf16_f32 v150, v196, v197
    v_mfma_f32_16x16x32_bf16 v[52:55], v[180:183], v[156:159], v[52:55]
    v_exp_f32 v199, v127
    v_mfma_f32_16x16x32_bf16 v[24:27], v[184:187], v[152:155], v[24:27]
    ds_read_b64_tr_b16 v[176:177], v214 offset:49152
    ds_read_b64_tr_b16 v[178:179], v214 offset:53248
    ds_read_b64_tr_b16 v[180:181], v214 offset:57344
    ds_read_b64_tr_b16 v[182:183], v214 offset:61440
    v_mfma_f32_16x16x32_bf16 v[56:59], v[184:187], v[156:159], v[56:59]
    v_exp_f32 v192, v128
    v_mfma_f32_16x16x32_bf16 v[108:111], v[204:207], v[156:159], v[108:111]
    v_cvt_pk_bf16_f32 v151, v198, v199
    v_or3_b32 v221, v221, v149, v150
    v_mfma_f32_16x16x32_bf16 v[28:31], v[188:191], v[152:155], v[28:31]
    ds_read_b64_tr_b16 v[184:185], v215 offset:49152
    ds_read_b64_tr_b16 v[186:187], v215 offset:53248
    v_bitop3_b32 v221, v221, v151, s46 bitop3:0xa8
    v_cmp_ne_u32 vcc, 0, v221
    v_mfma_f32_16x16x32_bf16 v[60:63], v[188:191], v[156:159], v[60:63]
    s_cbranch_vccnz L_tr8
L_bk8:
    v_exp_f32 v193, v129
    ds_read_b64_tr_b16 v[64:65], v239 offset:0
    ds_read_b64_tr_b16 v[66:67], v239 offset:2048
    ds_read_b64_tr_b16 v[68:69], v239 offset:4096
    ds_read_b64_tr_b16 v[70:71], v239 offset:6144
    ds_read_b64_tr_b16 v[72:73], v239 offset:8192
    ds_read_b64_tr_b16 v[74:75], v239 offset:10240
    ds_read_b64_tr_b16 v[76:77], v239 offset:12288
    ds_read_b64_tr_b16 v[78:79], v239 offset:14336
    ds_read_b64_tr_b16 v[80:81], v239 offset:16384
    ds_read_b64_tr_b16 v[82:83], v239 offset:18432
    ds_read_b64_tr_b16 v[84:85], v239 offset:20480
    ds_read_b64_tr_b16 v[86:87], v239 offset:22528
    ds_read_b64_tr_b16 v[88:89], v239 offset:24576
    ds_read_b64_tr_b16 v[90:91], v239 offset:26624
    ds_read_b64_tr_b16 v[92:93], v239 offset:28672
    ds_read_b64_tr_b16 v[94:95], v239 offset:30720
    v_exp_f32 v194, v130
    v_cvt_pk_bf16_f32 v152, v192, v193
    v_exp_f32 v195, v131
    v_exp_f32 v196, v132
    v_cvt_pk_bf16_f32 v153, v194, v195
    v_exp_f32 v197, v133
    v_exp_f32 v198, v134
    v_cvt_pk_bf16_f32 v154, v196, v197
    v_exp_f32 v199, v135
    v_exp_f32 v192, v136
    v_cvt_pk_bf16_f32 v155, v198, v199
    v_exp_f32 v193, v137
    v_exp_f32 v194, v138
    v_cvt_pk_bf16_f32 v156, v192, v193
    v_exp_f32 v195, v139
    v_exp_f32 v196, v140
    v_cvt_pk_bf16_f32 v157, v194, v195
    v_exp_f32 v197, v141
    v_exp_f32 v198, v142
    v_cvt_pk_bf16_f32 v158, v196, v197
    v_exp_f32 v199, v143
    s_nop 0
    v_cvt_pk_bf16_f32 v159, v198, v199
    v_or3_b32 v221, v152, v153, v154
    v_or3_b32 v221, v221, v155, v156
    v_or3_b32 v221, v221, v157, v158
    v_bitop3_b32 v221, v221, v159, s46 bitop3:0xa8
    v_cmp_ne_u32 vcc, 0, v221
    s_cbranch_vccnz L_tr9
L_bk9:
    s_lshl_b32 s39, s38, 13
    v_add_u32 v223, s39, v237
    v_mfma_f32_16x16x32_bf16 v[104:107], v[204:207], v[144:147], v[104:107]
    v_mfma_f32_16x16x32_bf16 v[108:111], v[204:207], v[148:151], v[108:111]
    v_mfma_f32_16x16x32_bf16 v[104:107], v[204:207], v[152:155], v[104:107]
    v_mfma_f32_16x16x32_bf16 v[108:111], v[204:207], v[156:159], v[108:111]
    s_waitcnt lgkmcnt(0)
    v_mfma_f32_16x16x32_bf16 v[0:3], v[160:163], v[144:147], v[0:3]
    ds_read_b64_tr_b16 v[188:189], v215 offset:57344
    ds_read_b64_tr_b16 v[190:191], v215 offset:61440
    v_mfma_f32_16x16x32_bf16 v[32:35], v[160:163], v[148:151], v[32:35]
    v_mfma_f32_16x16x32_bf16 v[0:3], v[164:167], v[152:155], v[0:3]
    ds_read_b64_tr_b16 v[160:161], v216 offset:49152
    ds_read_b64_tr_b16 v[162:163], v216 offset:53248
    v_mfma_f32_16x16x32_bf16 v[32:35], v[164:167], v[156:159], v[32:35]
    s_barrier
    v_mfma_f32_16x16x32_bf16 v[4:7], v[168:171], v[144:147], v[4:7]
    ds_read_b64_tr_b16 v[164:165], v216 offset:57344
    ds_read_b64_tr_b16 v[166:167], v216 offset:61440
    v_mfma_f32_16x16x32_bf16 v[36:39], v[168:171], v[148:151], v[36:39]
    v_mfma_f32_16x16x32_bf16 v[4:7], v[172:175], v[152:155], v[4:7]
    ds_read_b64_tr_b16 v[168:169], v217 offset:49152
    ds_read_b64_tr_b16 v[170:171], v217 offset:53248
    v_rcp_f32 v220, v104
    v_mfma_f32_16x16x32_bf16 v[36:39], v[172:175], v[156:159], v[36:39]
    v_rcp_f32 v200, v108
    v_mfma_f32_16x16x32_bf16 v[8:11], v[176:179], v[144:147], v[8:11]
    ds_read_b64_tr_b16 v[172:173], v217 offset:57344
    ds_read_b64_tr_b16 v[174:175], v217 offset:61440
    v_mfma_f32_16x16x32_bf16 v[40:43], v[176:179], v[148:151], v[40:43]
    v_mfma_f32_16x16x32_bf16 v[8:11], v[180:183], v[152:155], v[8:11]
    ds_read_b64_tr_b16 v[176:177], v218 offset:49152
    ds_read_b64_tr_b16 v[178:179], v218 offset:53248
    v_mfma_f32_16x16x32_bf16 v[40:43], v[180:183], v[156:159], v[40:43]
    v_mfma_f32_16x16x32_bf16 v[12:15], v[184:187], v[144:147], v[12:15]
    ds_read_b64_tr_b16 v[180:181], v218 offset:57344
    ds_read_b64_tr_b16 v[182:183], v218 offset:61440
    v_mul_f32 v0, v0, v220
    v_mfma_f32_16x16x32_bf16 v[44:47], v[184:187], v[148:151], v[44:47]
    v_mul_f32 v1, v1, v220
    v_mul_f32 v2, v2, v220
    v_mul_f32 v3, v3, v220
    s_waitcnt lgkmcnt(12)
    v_mfma_f32_16x16x32_bf16 v[12:15], v[188:191], v[152:155], v[12:15]
    ds_read_b64_tr_b16 v[184:185], v219 offset:49152
    ds_read_b64_tr_b16 v[186:187], v219 offset:53248
    v_mul_f32 v4, v4, v220
    v_mfma_f32_16x16x32_bf16 v[44:47], v[188:191], v[156:159], v[44:47]
    v_mul_f32 v5, v5, v220
    v_mul_f32 v6, v6, v220
    v_mul_f32 v7, v7, v220
    s_waitcnt lgkmcnt(12)
    v_mfma_f32_16x16x32_bf16 v[16:19], v[160:163], v[144:147], v[16:19]
    ds_read_b64_tr_b16 v[188:189], v219 offset:57344
    ds_read_b64_tr_b16 v[190:191], v219 offset:61440
    v_cvt_pk_bf16_f32 v112, v0, v1
    v_mfma_f32_16x16x32_bf16 v[48:51], v[160:163], v[148:151], v[48:51]
    v_cvt_pk_bf16_f32 v113, v2, v3
    v_cvt_pk_bf16_f32 v114, v4, v5
    v_cvt_pk_bf16_f32 v115, v6, v7
    s_waitcnt lgkmcnt(12)
    v_mfma_f32_16x16x32_bf16 v[16:19], v[164:167], v[152:155], v[16:19]
    v_mul_f32 v32, v32, v200
    v_mul_f32 v33, v33, v200
    v_mul_f32 v34, v34, v200
    v_mfma_f32_16x16x32_bf16 v[48:51], v[164:167], v[156:159], v[48:51]
    v_mul_f32 v35, v35, v200
    ds_write_b128 v223, v[112:115] offset:16384
    v_mul_f32 v36, v36, v200
    s_waitcnt lgkmcnt(11)
    v_mfma_f32_16x16x32_bf16 v[20:23], v[168:171], v[144:147], v[20:23]
    v_mul_f32 v37, v37, v200
    v_mul_f32 v38, v38, v200
    v_mul_f32 v39, v39, v200
    v_mfma_f32_16x16x32_bf16 v[52:55], v[168:171], v[148:151], v[52:55]
    v_cvt_pk_bf16_f32 v128, v32, v33
    v_cvt_pk_bf16_f32 v129, v34, v35
    v_cvt_pk_bf16_f32 v130, v36, v37
    s_waitcnt lgkmcnt(9)
    v_mfma_f32_16x16x32_bf16 v[20:23], v[172:175], v[152:155], v[20:23]
    v_cvt_pk_bf16_f32 v131, v38, v39
    ds_write_b128 v223, v[128:131] offset:20480
    v_mul_f32 v8, v8, v220
    v_mfma_f32_16x16x32_bf16 v[52:55], v[172:175], v[156:159], v[52:55]
    v_mul_f32 v9, v9, v220
    v_mul_f32 v10, v10, v220
    v_mul_f32 v11, v11, v220
    s_waitcnt lgkmcnt(8)
    v_mfma_f32_16x16x32_bf16 v[24:27], v[176:179], v[144:147], v[24:27]
    v_mul_f32 v12, v12, v220
    v_mul_f32 v13, v13, v220
    v_mul_f32 v14, v14, v220
    v_mfma_f32_16x16x32_bf16 v[56:59], v[176:179], v[148:151], v[56:59]
    v_mul_f32 v15, v15, v220
    v_cvt_pk_bf16_f32 v116, v8, v9
    v_cvt_pk_bf16_f32 v117, v10, v11
    s_waitcnt lgkmcnt(6)
    v_mfma_f32_16x16x32_bf16 v[24:27], v[180:183], v[152:155], v[24:27]
    v_cvt_pk_bf16_f32 v118, v12, v13
    v_cvt_pk_bf16_f32 v119, v14, v15
    v_mul_f32 v40, v40, v200
    v_mfma_f32_16x16x32_bf16 v[56:59], v[180:183], v[156:159], v[56:59]
    v_mul_f32 v41, v41, v200
    v_mul_f32 v42, v42, v200
    v_mul_f32 v43, v43, v200
    s_waitcnt lgkmcnt(4)
    v_mfma_f32_16x16x32_bf16 v[28:31], v[184:187], v[144:147], v[28:31]
    ds_write_b128 v223, v[116:119] offset:17408
    v_mul_f32 v44, v44, v200
    v_mul_f32 v45, v45, v200
    v_mfma_f32_16x16x32_bf16 v[60:63], v[184:187], v[148:151], v[60:63]
    v_mul_f32 v46, v46, v200
    v_mul_f32 v47, v47, v200
    v_cvt_pk_bf16_f32 v132, v40, v41
    s_waitcnt lgkmcnt(3)
    v_mfma_f32_16x16x32_bf16 v[28:31], v[188:191], v[152:155], v[28:31]
    v_cvt_pk_bf16_f32 v133, v42, v43
    v_cvt_pk_bf16_f32 v134, v44, v45
    v_cvt_pk_bf16_f32 v135, v46, v47
    v_mfma_f32_16x16x32_bf16 v[60:63], v[188:191], v[156:159], v[60:63]
    ds_write_b128 v223, v[132:135] offset:21504
    v_mul_f32 v16, v16, v220
    v_mul_f32 v17, v17, v220
    v_mul_f32 v18, v18, v220
    v_mul_f32 v19, v19, v220
    v_mul_f32 v20, v20, v220
    v_mul_f32 v21, v21, v220
    v_mul_f32 v22, v22, v220
    v_mul_f32 v23, v23, v220
    v_cvt_pk_bf16_f32 v120, v16, v17
    v_cvt_pk_bf16_f32 v121, v18, v19
    v_cvt_pk_bf16_f32 v122, v20, v21
    v_cvt_pk_bf16_f32 v123, v22, v23
    v_mul_f32 v48, v48, v200
    v_mul_f32 v49, v49, v200
    v_mul_f32 v50, v50, v200
    v_mul_f32 v51, v51, v200
    ds_write_b128 v223, v[120:123] offset:18432
    v_mul_f32 v52, v52, v200
    v_mul_f32 v53, v53, v200
    v_mul_f32 v54, v54, v200
    v_mul_f32 v55, v55, v200
    v_cvt_pk_bf16_f32 v136, v48, v49
    v_cvt_pk_bf16_f32 v137, v50, v51
    v_cvt_pk_bf16_f32 v138, v52, v53
    v_cvt_pk_bf16_f32 v139, v54, v55
    ds_write_b128 v223, v[136:139] offset:22528
    v_mul_f32 v24, v24, v220
    v_mul_f32 v25, v25, v220
    v_mul_f32 v26, v26, v220
    v_mul_f32 v27, v27, v220
    v_mul_f32 v28, v28, v220
    v_mul_f32 v29, v29, v220
    v_mul_f32 v30, v30, v220
    v_mul_f32 v31, v31, v220
    v_cvt_pk_bf16_f32 v124, v24, v25
    v_cvt_pk_bf16_f32 v125, v26, v27
    v_cvt_pk_bf16_f32 v126, v28, v29
    v_cvt_pk_bf16_f32 v127, v30, v31
    v_mul_f32 v56, v56, v200
    v_mul_f32 v57, v57, v200
    v_mul_f32 v58, v58, v200
    v_mul_f32 v59, v59, v200
    ds_write_b128 v223, v[124:127] offset:19456
    v_mul_f32 v60, v60, v200
    v_mul_f32 v61, v61, v200
    v_mul_f32 v62, v62, v200
    v_mul_f32 v63, v63, v200
    v_cvt_pk_bf16_f32 v140, v56, v57
    v_cvt_pk_bf16_f32 v141, v58, v59
    v_cvt_pk_bf16_f32 v142, v60, v61
    v_cvt_pk_bf16_f32 v143, v62, v63
    ds_write_b128 v223, v[140:143] offset:23552
    v_add_u32 v52, 32768, v239
    v_mov_b32 v53, v237
    v_mov_b32 v57, v226
    v_lshlrev_b32 v56, 28, v226
    v_lshl_or_b32 v56, v226, 24, v56
    v_and_b32 v56, 0xf0000000, v56
    v_mov_b32 v58, 0
    s_waitcnt lgkmcnt(0)
    s_barrier
    ds_read_b128 v[96:99], v53 offset:16384
    ds_read_b128 v[128:131], v53 offset:24576
    ds_read_b128 v[160:163], v53 offset:32768
    ds_read_b128 v[192:195], v53 offset:40960
    ds_read_b128 v[224:227], v53 offset:8192
    ds_read_b128 v[100:103], v53 offset:17408
    ds_read_b128 v[132:135], v53 offset:25600
    ds_read_b128 v[164:167], v53 offset:33792
    ds_read_b128 v[196:199], v53 offset:41984
    ds_read_b128 v[228:231], v53 offset:9216
    s_waitcnt lgkmcnt(5)
    v_mfma_f32_16x16x32_bf16 v[0:3], v[64:67], v[96:99], 0
    ds_read_b128 v[104:107], v53 offset:18432
    v_mfma_f32_16x16x32_bf16 v[4:7], v[64:67], v[128:131], 0
    ds_read_b128 v[136:139], v53 offset:26624
    v_mfma_f32_16x16x32_bf16 v[8:11], v[64:67], v[160:163], 0
    ds_read_b128 v[168:171], v53 offset:34816
    v_mfma_f32_16x16x32_bf16 v[12:15], v[64:67], v[192:195], 0
    ds_read_b128 v[200:203], v53 offset:43008
    v_mfma_f32_16x16x32_bf16 v[16:19], v[64:67], v[224:227], 0
    ds_read_b128 v[232:235], v53 offset:10240
    s_waitcnt lgkmcnt(5)
    v_mfma_f32_16x16x32_bf16 v[0:3], v[68:71], v[100:103], v[0:3]
    ds_read_b128 v[108:111], v53 offset:19456
    v_mfma_f32_16x16x32_bf16 v[4:7], v[68:71], v[132:135], v[4:7]
    ds_read_b64_tr_b16 v[64:65], v52 offset:0
    ds_read_b128 v[140:143], v53 offset:27648
    v_mfma_f32_16x16x32_bf16 v[8:11], v[68:71], v[164:167], v[8:11]
    ds_read_b64_tr_b16 v[66:67], v52 offset:2048
    ds_read_b128 v[172:175], v53 offset:35840
    v_mfma_f32_16x16x32_bf16 v[12:15], v[68:71], v[196:199], v[12:15]
    ds_read_b128 v[204:207], v53 offset:44032
    v_mfma_f32_16x16x32_bf16 v[16:19], v[68:71], v[228:231], v[16:19]
    ds_read_b128 v[236:239], v53 offset:11264
    s_waitcnt lgkmcnt(7)
    v_mfma_f32_16x16x32_bf16 v[0:3], v[72:75], v[104:107], v[0:3]
    ds_read_b128 v[112:115], v53 offset:20480
    v_mfma_f32_16x16x32_bf16 v[4:7], v[72:75], v[136:139], v[4:7]
    ds_read_b64_tr_b16 v[68:69], v52 offset:4096
    ds_read_b128 v[144:147], v53 offset:28672
    v_mfma_f32_16x16x32_bf16 v[8:11], v[72:75], v[168:171], v[8:11]
    ds_read_b64_tr_b16 v[70:71], v52 offset:6144
    ds_read_b128 v[176:179], v53 offset:36864
    v_mfma_f32_16x16x32_bf16 v[12:15], v[72:75], v[200:203], v[12:15]
    ds_read_b128 v[208:211], v53 offset:45056
    v_mfma_f32_16x16x32_bf16 v[16:19], v[72:75], v[232:235], v[16:19]
    ds_read_b128 v[240:243], v53 offset:0
    s_waitcnt lgkmcnt(7)
    v_mfma_f32_16x16x32_bf16 v[0:3], v[76:79], v[108:111], v[0:3]
    ds_read_b128 v[116:119], v53 offset:21504
    v_mfma_f32_16x16x32_bf16 v[4:7], v[76:79], v[140:143], v[4:7]
    ds_read_b64_tr_b16 v[72:73], v52 offset:8192
    ds_read_b128 v[148:151], v53 offset:29696
    v_mfma_f32_16x16x32_bf16 v[8:11], v[76:79], v[172:175], v[8:11]
    ds_read_b64_tr_b16 v[74:75], v52 offset:10240
    ds_read_b128 v[180:183], v53 offset:37888
    v_mfma_f32_16x16x32_bf16 v[12:15], v[76:79], v[204:207], v[12:15]
    ds_read_b128 v[212:215], v53 offset:46080
    v_mfma_f32_16x16x32_bf16 v[16:19], v[76:79], v[236:239], v[16:19]
    ds_read_b128 v[244:247], v53 offset:1024
    s_waitcnt lgkmcnt(7)
    v_mfma_f32_16x16x32_bf16 v[0:3], v[80:83], v[112:115], v[0:3]
    ds_read_b128 v[120:123], v53 offset:22528
    v_mfma_f32_16x16x32_bf16 v[4:7], v[80:83], v[144:147], v[4:7]
    ds_read_b64_tr_b16 v[76:77], v52 offset:12288
    ds_read_b128 v[152:155], v53 offset:30720
    v_mfma_f32_16x16x32_bf16 v[8:11], v[80:83], v[176:179], v[8:11]
    ds_read_b64_tr_b16 v[78:79], v52 offset:14336
    ds_read_b128 v[184:187], v53 offset:38912
    v_mfma_f32_16x16x32_bf16 v[12:15], v[80:83], v[208:211], v[12:15]
    ds_read_b128 v[216:219], v53 offset:47104
    v_mfma_f32_16x16x32_bf16 v[16:19], v[80:83], v[240:243], v[16:19]
    ds_read_b128 v[248:251], v53 offset:2048
    s_waitcnt lgkmcnt(7)
    v_mfma_f32_16x16x32_bf16 v[0:3], v[84:87], v[116:119], v[0:3]
    ds_read_b128 v[124:127], v53 offset:23552
    v_mfma_f32_16x16x32_bf16 v[4:7], v[84:87], v[148:151], v[4:7]
    ds_read_b64_tr_b16 v[80:81], v52 offset:16384
    ds_read_b128 v[156:159], v53 offset:31744
    v_mfma_f32_16x16x32_bf16 v[8:11], v[84:87], v[180:183], v[8:11]
    ds_read_b64_tr_b16 v[82:83], v52 offset:18432
    ds_read_b128 v[188:191], v53 offset:39936
    v_mfma_f32_16x16x32_bf16 v[12:15], v[84:87], v[212:215], v[12:15]
    ds_read_b128 v[220:223], v53 offset:48128
    v_mfma_f32_16x16x32_bf16 v[16:19], v[84:87], v[244:247], v[16:19]
    ds_read_b128 v[252:255], v53 offset:3072
    s_waitcnt lgkmcnt(7)
    v_mfma_f32_16x16x32_bf16 v[0:3], v[88:91], v[120:123], v[0:3]
    v_mfma_f32_16x16x32_bf16 v[4:7], v[88:91], v[152:155], v[4:7]
    ds_read_b64_tr_b16 v[84:85], v52 offset:20480
    v_mfma_f32_16x16x32_bf16 v[8:11], v[88:91], v[184:187], v[8:11]
    ds_read_b64_tr_b16 v[86:87], v52 offset:22528
    v_mfma_f32_16x16x32_bf16 v[12:15], v[88:91], v[216:219], v[12:15]
    v_mfma_f32_16x16x32_bf16 v[16:19], v[88:91], v[248:251], v[16:19]
    s_waitcnt lgkmcnt(2)
    v_mfma_f32_16x16x32_bf16 v[0:3], v[92:95], v[124:127], v[0:3]
    v_mfma_f32_16x16x32_bf16 v[4:7], v[92:95], v[156:159], v[4:7]
    ds_read_b64_tr_b16 v[88:89], v52 offset:24576
    v_mfma_f32_16x16x32_bf16 v[8:11], v[92:95], v[188:191], v[8:11]
    ds_read_b64_tr_b16 v[90:91], v52 offset:26624
    v_mfma_f32_16x16x32_bf16 v[12:15], v[92:95], v[220:223], v[12:15]
    v_mfma_f32_16x16x32_bf16 v[16:19], v[92:95], v[252:255], v[16:19]
    ds_read_b64_tr_b16 v[92:93], v52 offset:28672
    ds_read_b64_tr_b16 v[94:95], v52 offset:30720
    v_add_u32 v52, 0xffff0000, v52
    v_mfma_f32_16x16x32_bf16 v[20:23], v[64:67], v[96:99], 0
    v_mfma_f32_16x16x32_bf16 v[24:27], v[64:67], v[128:131], 0
    v_mfma_f32_16x16x32_bf16 v[28:31], v[64:67], v[160:163], 0
    v_mfma_f32_16x16x32_bf16 v[32:35], v[64:67], v[192:195], 0
    v_mfma_f32_16x16x32_bf16 v[36:39], v[64:67], v[224:227], 0
    s_waitcnt lgkmcnt(0)
    s_barrier
    ds_read_b64 v[54:55], v58 offset:57344
    v_mfma_f32_16x16x32_bf16 v[20:23], v[68:71], v[100:103], v[20:23]
    v_mfma_f32_16x16x32_bf16 v[24:27], v[68:71], v[132:135], v[24:27]
    ds_read_b64_tr_b16 v[64:65], v52 offset:0
    v_mfma_f32_16x16x32_bf16 v[28:31], v[68:71], v[164:167], v[28:31]
    ds_read_b64_tr_b16 v[66:67], v52 offset:2048
    v_mfma_f32_16x16x32_bf16 v[32:35], v[68:71], v[196:199], v[32:35]
    v_mfma_f32_16x16x32_bf16 v[36:39], v[68:71], v[228:231], v[36:39]
    v_mfma_f32_16x16x32_bf16 v[20:23], v[72:75], v[104:107], v[20:23]
    v_cvt_pk_bf16_f32 v40, v0, v1
    v_mfma_f32_16x16x32_bf16 v[24:27], v[72:75], v[136:139], v[24:27]
    ds_read_b64_tr_b16 v[68:69], v52 offset:4096
    v_mfma_f32_16x16x32_bf16 v[28:31], v[72:75], v[168:171], v[28:31]
    ds_read_b64_tr_b16 v[70:71], v52 offset:6144
    v_mfma_f32_16x16x32_bf16 v[32:35], v[72:75], v[200:203], v[32:35]
    v_cvt_pk_bf16_f32 v41, v2, v3
    v_mfma_f32_16x16x32_bf16 v[36:39], v[72:75], v[232:235], v[36:39]
    v_cvt_pk_bf16_f32 v42, v4, v5
    v_mfma_f32_16x16x32_bf16 v[20:23], v[76:79], v[108:111], v[20:23]
    v_cvt_pk_bf16_f32 v43, v6, v7
    v_mfma_f32_16x16x32_bf16 v[24:27], v[76:79], v[140:143], v[24:27]
    ds_read_b64_tr_b16 v[72:73], v52 offset:8192
    v_mfma_f32_16x16x32_bf16 v[28:31], v[76:79], v[172:175], v[28:31]
    ds_read_b64_tr_b16 v[74:75], v52 offset:10240
    v_mfma_f32_16x16x32_bf16 v[32:35], v[76:79], v[204:207], v[32:35]
    buffer_store_dwordx4 v[40:43], v53, s[28:31], s58 offen sc1
    v_mfma_f32_16x16x32_bf16 v[36:39], v[76:79], v[236:239], v[36:39]
    s_add_u32 s58, s58, 65536
    v_mfma_f32_16x16x32_bf16 v[20:23], v[80:83], v[112:115], v[20:23]
    v_cvt_pk_bf16_f32 v44, v12, v13
    v_mfma_f32_16x16x32_bf16 v[24:27], v[80:83], v[144:147], v[24:27]
    ds_read_b64_tr_b16 v[76:77], v52 offset:12288
    v_mfma_f32_16x16x32_bf16 v[28:31], v[80:83], v[176:179], v[28:31]
    ds_read_b64_tr_b16 v[78:79], v52 offset:14336
    v_mfma_f32_16x16x32_bf16 v[32:35], v[80:83], v[208:211], v[32:35]
    v_cvt_pk_bf16_f32 v45, v14, v15
    v_mfma_f32_16x16x32_bf16 v[36:39], v[80:83], v[240:243], v[36:39]
    v_cvt_pk_bf16_f32 v46, v16, v17
    v_mfma_f32_16x16x32_bf16 v[20:23], v[84:87], v[116:119], v[20:23]
    v_cvt_pk_bf16_f32 v47, v18, v19
    v_mfma_f32_16x16x32_bf16 v[24:27], v[84:87], v[148:151], v[24:27]
    ds_read_b64_tr_b16 v[80:81], v52 offset:16384
    v_mfma_f32_16x16x32_bf16 v[28:31], v[84:87], v[180:183], v[28:31]
    ds_read_b64_tr_b16 v[82:83], v52 offset:18432
    v_mfma_f32_16x16x32_bf16 v[32:35], v[84:87], v[212:215], v[32:35]
    buffer_store_dwordx4 v[44:47], v53, s[28:31], s58 offen sc1
    v_mfma_f32_16x16x32_bf16 v[36:39], v[84:87], v[244:247], v[36:39]
    s_add_u32 s58, s58, 65536
    v_mfma_f32_16x16x32_bf16 v[20:23], v[88:91], v[120:123], v[20:23]
    v_cvt_pk_bf16_f32 v48, v8, v9
    v_mfma_f32_16x16x32_bf16 v[24:27], v[88:91], v[152:155], v[24:27]
    ds_read_b64_tr_b16 v[84:85], v52 offset:20480
    v_mfma_f32_16x16x32_bf16 v[28:31], v[88:91], v[184:187], v[28:31]
    ds_read_b64_tr_b16 v[86:87], v52 offset:22528
    v_mfma_f32_16x16x32_bf16 v[32:35], v[88:91], v[216:219], v[32:35]
    v_cvt_pk_bf16_f32 v49, v10, v11
    v_mfma_f32_16x16x32_bf16 v[36:39], v[88:91], v[248:251], v[36:39]
    v_mfma_f32_16x16x32_bf16 v[20:23], v[92:95], v[124:127], v[20:23]
    v_mfma_f32_16x16x32_bf16 v[24:27], v[92:95], v[156:159], v[24:27]
    ds_read_b64_tr_b16 v[88:89], v52 offset:24576
    v_mfma_f32_16x16x32_bf16 v[28:31], v[92:95], v[188:191], v[28:31]
    ds_read_b64_tr_b16 v[90:91], v52 offset:26624
    v_mfma_f32_16x16x32_bf16 v[32:35], v[92:95], v[220:223], v[32:35]
    v_mfma_f32_16x16x32_bf16 v[36:39], v[92:95], v[252:255], v[36:39]
    ds_read_b64_tr_b16 v[92:93], v52 offset:28672
    ds_read_b64_tr_b16 v[94:95], v52 offset:30720
    v_add_u32 v52, 0x8000, v52
    s_waitcnt lgkmcnt(14)
    v_mfma_f32_16x16x32_bf16 v[0:3], v[64:67], v[96:99], 0
    v_mfma_f32_16x16x32_bf16 v[4:7], v[64:67], v[128:131], 0
    v_mfma_f32_16x16x32_bf16 v[8:11], v[64:67], v[160:163], 0
    v_mfma_f32_16x16x32_bf16 v[12:15], v[64:67], v[192:195], 0
    v_mfma_f32_16x16x32_bf16 v[16:19], v[64:67], v[224:227], 0
    s_waitcnt lgkmcnt(0)
    s_barrier
    v_mfma_f32_16x16x32_bf16 v[0:3], v[68:71], v[100:103], v[0:3]
    v_mfma_f32_16x16x32_bf16 v[4:7], v[68:71], v[132:135], v[4:7]
    ds_read_b64_tr_b16 v[64:65], v52 offset:0
    v_mfma_f32_16x16x32_bf16 v[8:11], v[68:71], v[164:167], v[8:11]
    ds_read_b64_tr_b16 v[66:67], v52 offset:2048
    v_mfma_f32_16x16x32_bf16 v[12:15], v[68:71], v[196:199], v[12:15]
    v_mfma_f32_16x16x32_bf16 v[16:19], v[68:71], v[228:231], v[16:19]
    v_mfma_f32_16x16x32_bf16 v[0:3], v[72:75], v[104:107], v[0:3]
    v_cvt_pk_bf16_f32 v40, v20, v21
    v_mfma_f32_16x16x32_bf16 v[4:7], v[72:75], v[136:139], v[4:7]
    ds_read_b64_tr_b16 v[68:69], v52 offset:4096
    v_mfma_f32_16x16x32_bf16 v[8:11], v[72:75], v[168:171], v[8:11]
    ds_read_b64_tr_b16 v[70:71], v52 offset:6144
    v_mfma_f32_16x16x32_bf16 v[12:15], v[72:75], v[200:203], v[12:15]
    v_cvt_pk_bf16_f32 v41, v22, v23
    v_mfma_f32_16x16x32_bf16 v[16:19], v[72:75], v[232:235], v[16:19]
    v_cvt_pk_bf16_f32 v42, v24, v25
    v_mfma_f32_16x16x32_bf16 v[0:3], v[76:79], v[108:111], v[0:3]
    v_cvt_pk_bf16_f32 v43, v26, v27
    v_mfma_f32_16x16x32_bf16 v[4:7], v[76:79], v[140:143], v[4:7]
    ds_read_b64_tr_b16 v[72:73], v52 offset:8192
    v_mfma_f32_16x16x32_bf16 v[8:11], v[76:79], v[172:175], v[8:11]
    ds_read_b64_tr_b16 v[74:75], v52 offset:10240
    v_mfma_f32_16x16x32_bf16 v[12:15], v[76:79], v[204:207], v[12:15]
    buffer_store_dwordx4 v[40:43], v53, s[28:31], s58 offen sc1
    v_mfma_f32_16x16x32_bf16 v[16:19], v[76:79], v[236:239], v[16:19]
    s_add_u32 s58, s58, 65536
    v_mfma_f32_16x16x32_bf16 v[0:3], v[80:83], v[112:115], v[0:3]
    v_cvt_pk_bf16_f32 v44, v32, v33
    v_mfma_f32_16x16x32_bf16 v[4:7], v[80:83], v[144:147], v[4:7]
    ds_read_b64_tr_b16 v[76:77], v52 offset:12288
    v_mfma_f32_16x16x32_bf16 v[8:11], v[80:83], v[176:179], v[8:11]
    ds_read_b64_tr_b16 v[78:79], v52 offset:14336
    v_mfma_f32_16x16x32_bf16 v[12:15], v[80:83], v[208:211], v[12:15]
    v_cvt_pk_bf16_f32 v45, v34, v35
    v_mfma_f32_16x16x32_bf16 v[16:19], v[80:83], v[240:243], v[16:19]
    v_cvt_pk_bf16_f32 v46, v36, v37
    v_mfma_f32_16x16x32_bf16 v[0:3], v[84:87], v[116:119], v[0:3]
    v_cvt_pk_bf16_f32 v47, v38, v39
    v_mfma_f32_16x16x32_bf16 v[4:7], v[84:87], v[148:151], v[4:7]
    ds_read_b64_tr_b16 v[80:81], v52 offset:16384
    v_mfma_f32_16x16x32_bf16 v[8:11], v[84:87], v[180:183], v[8:11]
    ds_read_b64_tr_b16 v[82:83], v52 offset:18432
    v_mfma_f32_16x16x32_bf16 v[12:15], v[84:87], v[212:215], v[12:15]
    buffer_store_dwordx4 v[44:47], v53, s[28:31], s58 offen sc1
    v_mfma_f32_16x16x32_bf16 v[16:19], v[84:87], v[244:247], v[16:19]
    s_add_u32 s58, s58, 65536
    v_mfma_f32_16x16x32_bf16 v[0:3], v[88:91], v[120:123], v[0:3]
    v_cvt_pk_bf16_f32 v50, v28, v29
    v_mfma_f32_16x16x32_bf16 v[4:7], v[88:91], v[152:155], v[4:7]
    ds_read_b64_tr_b16 v[84:85], v52 offset:20480
    v_mfma_f32_16x16x32_bf16 v[8:11], v[88:91], v[184:187], v[8:11]
    ds_read_b64_tr_b16 v[86:87], v52 offset:22528
    v_mfma_f32_16x16x32_bf16 v[12:15], v[88:91], v[216:219], v[12:15]
    v_cvt_pk_bf16_f32 v51, v30, v31
    v_mfma_f32_16x16x32_bf16 v[16:19], v[88:91], v[248:251], v[16:19]
    buffer_store_dwordx4 v[48:51], v53, s[28:31], s58 offen sc1
    v_mfma_f32_16x16x32_bf16 v[0:3], v[92:95], v[124:127], v[0:3]
    s_add_u32 s58, s58, 65536
    v_mfma_f32_16x16x32_bf16 v[4:7], v[92:95], v[156:159], v[4:7]
    ds_read_b64_tr_b16 v[88:89], v52 offset:24576
    v_mfma_f32_16x16x32_bf16 v[8:11], v[92:95], v[188:191], v[8:11]
    ds_read_b64_tr_b16 v[90:91], v52 offset:26624
    v_mfma_f32_16x16x32_bf16 v[12:15], v[92:95], v[220:223], v[12:15]
    v_mfma_f32_16x16x32_bf16 v[16:19], v[92:95], v[252:255], v[16:19]
    ds_read_b64_tr_b16 v[92:93], v52 offset:28672
    ds_read_b64_tr_b16 v[94:95], v52 offset:30720
    v_add_u32 v52, 0x8000, v52
    s_waitcnt lgkmcnt(14)
    v_mfma_f32_16x16x32_bf16 v[20:23], v[64:67], v[96:99], 0
    v_mfma_f32_16x16x32_bf16 v[24:27], v[64:67], v[128:131], 0
    v_mfma_f32_16x16x32_bf16 v[28:31], v[64:67], v[160:163], 0
    v_mfma_f32_16x16x32_bf16 v[32:35], v[64:67], v[192:195], 0
    v_mfma_f32_16x16x32_bf16 v[36:39], v[64:67], v[224:227], 0
    s_waitcnt lgkmcnt(0)
    s_barrier
    v_mfma_f32_16x16x32_bf16 v[20:23], v[68:71], v[100:103], v[20:23]
    v_mfma_f32_16x16x32_bf16 v[24:27], v[68:71], v[132:135], v[24:27]
    ds_read_b64_tr_b16 v[64:65], v52 offset:0
    v_mfma_f32_16x16x32_bf16 v[28:31], v[68:71], v[164:167], v[28:31]
    ds_read_b64_tr_b16 v[66:67], v52 offset:2048
    v_mfma_f32_16x16x32_bf16 v[32:35], v[68:71], v[196:199], v[32:35]
    v_mfma_f32_16x16x32_bf16 v[36:39], v[68:71], v[228:231], v[36:39]
    v_mfma_f32_16x16x32_bf16 v[20:23], v[72:75], v[104:107], v[20:23]
    v_cvt_pk_bf16_f32 v40, v0, v1
    v_mfma_f32_16x16x32_bf16 v[24:27], v[72:75], v[136:139], v[24:27]
    ds_read_b64_tr_b16 v[68:69], v52 offset:4096
    v_mfma_f32_16x16x32_bf16 v[28:31], v[72:75], v[168:171], v[28:31]
    ds_read_b64_tr_b16 v[70:71], v52 offset:6144
    v_mfma_f32_16x16x32_bf16 v[32:35], v[72:75], v[200:203], v[32:35]
    v_cvt_pk_bf16_f32 v41, v2, v3
    v_mfma_f32_16x16x32_bf16 v[36:39], v[72:75], v[232:235], v[36:39]
    v_cvt_pk_bf16_f32 v42, v4, v5
    v_mfma_f32_16x16x32_bf16 v[20:23], v[76:79], v[108:111], v[20:23]
    v_cvt_pk_bf16_f32 v43, v6, v7
    v_mfma_f32_16x16x32_bf16 v[24:27], v[76:79], v[140:143], v[24:27]
    ds_read_b64_tr_b16 v[72:73], v52 offset:8192
    v_mfma_f32_16x16x32_bf16 v[28:31], v[76:79], v[172:175], v[28:31]
    ds_read_b64_tr_b16 v[74:75], v52 offset:10240
    v_mfma_f32_16x16x32_bf16 v[32:35], v[76:79], v[204:207], v[32:35]
    buffer_store_dwordx4 v[40:43], v53, s[28:31], s58 offen sc1
    v_mfma_f32_16x16x32_bf16 v[36:39], v[76:79], v[236:239], v[36:39]
    s_add_u32 s58, s58, 65536
    v_mfma_f32_16x16x32_bf16 v[20:23], v[80:83], v[112:115], v[20:23]
    v_cvt_pk_bf16_f32 v44, v12, v13
    v_mfma_f32_16x16x32_bf16 v[24:27], v[80:83], v[144:147], v[24:27]
    ds_read_b64_tr_b16 v[76:77], v52 offset:12288
    v_mfma_f32_16x16x32_bf16 v[28:31], v[80:83], v[176:179], v[28:31]
    ds_read_b64_tr_b16 v[78:79], v52 offset:14336
    v_mfma_f32_16x16x32_bf16 v[32:35], v[80:83], v[208:211], v[32:35]
    v_cvt_pk_bf16_f32 v45, v14, v15
    v_mfma_f32_16x16x32_bf16 v[36:39], v[80:83], v[240:243], v[36:39]
    v_cvt_pk_bf16_f32 v46, v16, v17
    v_mfma_f32_16x16x32_bf16 v[20:23], v[84:87], v[116:119], v[20:23]
    v_cvt_pk_bf16_f32 v47, v18, v19
    v_mfma_f32_16x16x32_bf16 v[24:27], v[84:87], v[148:151], v[24:27]
    ds_read_b64_tr_b16 v[80:81], v52 offset:16384
    v_mfma_f32_16x16x32_bf16 v[28:31], v[84:87], v[180:183], v[28:31]
    ds_read_b64_tr_b16 v[82:83], v52 offset:18432
    v_mfma_f32_16x16x32_bf16 v[32:35], v[84:87], v[212:215], v[32:35]
    buffer_store_dwordx4 v[44:47], v53, s[28:31], s58 offen sc1
    v_mfma_f32_16x16x32_bf16 v[36:39], v[84:87], v[244:247], v[36:39]
    s_add_u32 s58, s58, 65536
    v_mfma_f32_16x16x32_bf16 v[20:23], v[88:91], v[120:123], v[20:23]
    v_cvt_pk_bf16_f32 v48, v8, v9
    v_mfma_f32_16x16x32_bf16 v[24:27], v[88:91], v[152:155], v[24:27]
    ds_read_b64_tr_b16 v[84:85], v52 offset:20480
    v_mfma_f32_16x16x32_bf16 v[28:31], v[88:91], v[184:187], v[28:31]
    ds_read_b64_tr_b16 v[86:87], v52 offset:22528
    v_mfma_f32_16x16x32_bf16 v[32:35], v[88:91], v[216:219], v[32:35]
    v_cvt_pk_bf16_f32 v49, v10, v11
    v_mfma_f32_16x16x32_bf16 v[36:39], v[88:91], v[248:251], v[36:39]
    v_mfma_f32_16x16x32_bf16 v[20:23], v[92:95], v[124:127], v[20:23]
    v_mfma_f32_16x16x32_bf16 v[24:27], v[92:95], v[156:159], v[24:27]
    ds_read_b64_tr_b16 v[88:89], v52 offset:24576
    v_mfma_f32_16x16x32_bf16 v[28:31], v[92:95], v[188:191], v[28:31]
    ds_read_b64_tr_b16 v[90:91], v52 offset:26624
    v_mfma_f32_16x16x32_bf16 v[32:35], v[92:95], v[220:223], v[32:35]
    v_mfma_f32_16x16x32_bf16 v[36:39], v[92:95], v[252:255], v[36:39]
    ds_read_b64_tr_b16 v[92:93], v52 offset:28672
    ds_read_b64_tr_b16 v[94:95], v52 offset:30720
    v_add_u32 v52, 0xfffe0000, v52
    s_waitcnt lgkmcnt(14)
    v_mfma_f32_16x16x32_bf16 v[0:3], v[64:67], v[96:99], 0
    v_mfma_f32_16x16x32_bf16 v[4:7], v[64:67], v[128:131], 0
    v_mfma_f32_16x16x32_bf16 v[8:11], v[64:67], v[160:163], 0
    v_mfma_f32_16x16x32_bf16 v[12:15], v[64:67], v[192:195], 0
    v_mfma_f32_16x16x32_bf16 v[16:19], v[64:67], v[224:227], 0
    s_barrier
    s_waitcnt lgkmcnt(12)
    v_mfma_f32_16x16x32_bf16 v[0:3], v[68:71], v[100:103], v[0:3]
    v_mfma_f32_16x16x32_bf16 v[4:7], v[68:71], v[132:135], v[4:7]
    ds_read_b64_tr_b16 v[64:65], v52 offset:0
    v_mfma_f32_16x16x32_bf16 v[8:11], v[68:71], v[164:167], v[8:11]
    ds_read_b64_tr_b16 v[66:67], v52 offset:2048
    v_mfma_f32_16x16x32_bf16 v[12:15], v[68:71], v[196:199], v[12:15]
    v_mfma_f32_16x16x32_bf16 v[16:19], v[68:71], v[228:231], v[16:19]
    s_waitcnt lgkmcnt(12)
    v_mfma_f32_16x16x32_bf16 v[0:3], v[72:75], v[104:107], v[0:3]
    v_cvt_pk_bf16_f32 v40, v20, v21
    v_mfma_f32_16x16x32_bf16 v[4:7], v[72:75], v[136:139], v[4:7]
    ds_read_b64_tr_b16 v[68:69], v52 offset:4096
    v_mfma_f32_16x16x32_bf16 v[8:11], v[72:75], v[168:171], v[8:11]
    ds_read_b64_tr_b16 v[70:71], v52 offset:6144
    v_mfma_f32_16x16x32_bf16 v[12:15], v[72:75], v[200:203], v[12:15]
    v_cvt_pk_bf16_f32 v41, v22, v23
    v_mfma_f32_16x16x32_bf16 v[16:19], v[72:75], v[232:235], v[16:19]
    v_cvt_pk_bf16_f32 v42, v24, v25
    s_waitcnt lgkmcnt(12)
    v_mfma_f32_16x16x32_bf16 v[0:3], v[76:79], v[108:111], v[0:3]
    v_cvt_pk_bf16_f32 v43, v26, v27
    v_mfma_f32_16x16x32_bf16 v[4:7], v[76:79], v[140:143], v[4:7]
    ds_read_b64_tr_b16 v[72:73], v52 offset:8192
    v_mfma_f32_16x16x32_bf16 v[8:11], v[76:79], v[172:175], v[8:11]
    ds_read_b64_tr_b16 v[74:75], v52 offset:10240
    v_mfma_f32_16x16x32_bf16 v[12:15], v[76:79], v[204:207], v[12:15]
    buffer_store_dwordx4 v[40:43], v53, s[28:31], s58 offen sc1
    v_mfma_f32_16x16x32_bf16 v[16:19], v[76:79], v[236:239], v[16:19]
    s_add_u32 s58, s58, 65536
    s_waitcnt lgkmcnt(12)
    v_mfma_f32_16x16x32_bf16 v[0:3], v[80:83], v[112:115], v[0:3]
    v_cvt_pk_bf16_f32 v44, v32, v33
    v_mfma_f32_16x16x32_bf16 v[4:7], v[80:83], v[144:147], v[4:7]
    ds_read_b64_tr_b16 v[76:77], v52 offset:12288
    v_mfma_f32_16x16x32_bf16 v[8:11], v[80:83], v[176:179], v[8:11]
    ds_read_b64_tr_b16 v[78:79], v52 offset:14336
    v_mfma_f32_16x16x32_bf16 v[12:15], v[80:83], v[208:211], v[12:15]
    v_cvt_pk_bf16_f32 v45, v34, v35
    v_mfma_f32_16x16x32_bf16 v[16:19], v[80:83], v[240:243], v[16:19]
    v_cvt_pk_bf16_f32 v46, v36, v37
    s_waitcnt lgkmcnt(12)
    v_mfma_f32_16x16x32_bf16 v[0:3], v[84:87], v[116:119], v[0:3]
    v_cvt_pk_bf16_f32 v47, v38, v39
    v_mfma_f32_16x16x32_bf16 v[4:7], v[84:87], v[148:151], v[4:7]
    ds_read_b64_tr_b16 v[80:81], v52 offset:16384
    v_mfma_f32_16x16x32_bf16 v[8:11], v[84:87], v[180:183], v[8:11]
    ds_read_b64_tr_b16 v[82:83], v52 offset:18432
    v_mfma_f32_16x16x32_bf16 v[12:15], v[84:87], v[212:215], v[12:15]
    buffer_store_dwordx4 v[44:47], v53, s[28:31], s58 offen sc1
    v_mfma_f32_16x16x32_bf16 v[16:19], v[84:87], v[244:247], v[16:19]
    s_add_u32 s58, s58, 65536
    s_waitcnt lgkmcnt(12)
    v_mfma_f32_16x16x32_bf16 v[0:3], v[88:91], v[120:123], v[0:3]
    v_cvt_pk_bf16_f32 v50, v28, v29
    v_mfma_f32_16x16x32_bf16 v[4:7], v[88:91], v[152:155], v[4:7]
    ds_read_b64_tr_b16 v[84:85], v52 offset:20480
    v_mfma_f32_16x16x32_bf16 v[8:11], v[88:91], v[184:187], v[8:11]
    ds_read_b64_tr_b16 v[86:87], v52 offset:22528
    v_mfma_f32_16x16x32_bf16 v[12:15], v[88:91], v[216:219], v[12:15]
    v_cvt_pk_bf16_f32 v51, v30, v31
    v_mfma_f32_16x16x32_bf16 v[16:19], v[88:91], v[248:251], v[16:19]
    buffer_store_dwordx4 v[48:51], v53, s[28:31], s58 offen sc1
    s_waitcnt lgkmcnt(12)
    v_mfma_f32_16x16x32_bf16 v[0:3], v[92:95], v[124:127], v[0:3]
    s_add_u32 s58, s58, 65536
    v_mfma_f32_16x16x32_bf16 v[4:7], v[92:95], v[156:159], v[4:7]
    ds_read_b64_tr_b16 v[88:89], v52 offset:24576
    v_mfma_f32_16x16x32_bf16 v[8:11], v[92:95], v[188:191], v[8:11]
    ds_read_b64_tr_b16 v[90:91], v52 offset:26624
    v_mfma_f32_16x16x32_bf16 v[12:15], v[92:95], v[220:223], v[12:15]
    v_mfma_f32_16x16x32_bf16 v[16:19], v[92:95], v[252:255], v[16:19]
    ds_read_b64_tr_b16 v[92:93], v52 offset:28672
    ds_read_b64_tr_b16 v[94:95], v52 offset:30720
    v_add_u32 v52, 0x8000, v52
    s_waitcnt lgkmcnt(14)
    v_mfma_f32_16x16x32_bf16 v[20:23], v[64:67], v[96:99], 0
    v_mfma_f32_16x16x32_bf16 v[24:27], v[64:67], v[128:131], 0
    v_mfma_f32_16x16x32_bf16 v[28:31], v[64:67], v[160:163], 0
    v_mfma_f32_16x16x32_bf16 v[32:35], v[64:67], v[192:195], 0
    v_mfma_f32_16x16x32_bf16 v[36:39], v[64:67], v[224:227], 0
    s_barrier
    s_waitcnt lgkmcnt(12)
    v_mfma_f32_16x16x32_bf16 v[20:23], v[68:71], v[100:103], v[20:23]
    v_mfma_f32_16x16x32_bf16 v[24:27], v[68:71], v[132:135], v[24:27]
    ds_read_b64_tr_b16 v[64:65], v52 offset:0
    v_mfma_f32_16x16x32_bf16 v[28:31], v[68:71], v[164:167], v[28:31]
    ds_read_b64_tr_b16 v[66:67], v52 offset:2048
    v_mfma_f32_16x16x32_bf16 v[32:35], v[68:71], v[196:199], v[32:35]
    v_mfma_f32_16x16x32_bf16 v[36:39], v[68:71], v[228:231], v[36:39]
    s_waitcnt lgkmcnt(12)
    v_mfma_f32_16x16x32_bf16 v[20:23], v[72:75], v[104:107], v[20:23]
    s_waitcnt vmcnt(5)
    buffer_store_dwordx2 v[54:55], v56, s[28:31], s45 offen offset:0 sc1
    v_mfma_f32_16x16x32_bf16 v[24:27], v[72:75], v[136:139], v[24:27]
    ds_read_b64_tr_b16 v[68:69], v52 offset:4096
    v_mfma_f32_16x16x32_bf16 v[28:31], v[72:75], v[168:171], v[28:31]
    ds_read_b64_tr_b16 v[70:71], v52 offset:6144
    v_mfma_f32_16x16x32_bf16 v[32:35], v[72:75], v[200:203], v[32:35]
    v_cvt_pk_bf16_f32 v40, v0, v1
    v_mfma_f32_16x16x32_bf16 v[36:39], v[72:75], v[232:235], v[36:39]
    v_cvt_pk_bf16_f32 v41, v2, v3
    s_waitcnt lgkmcnt(12)
    v_mfma_f32_16x16x32_bf16 v[20:23], v[76:79], v[108:111], v[20:23]
    v_cvt_pk_bf16_f32 v42, v4, v5
    v_mfma_f32_16x16x32_bf16 v[24:27], v[76:79], v[140:143], v[24:27]
    ds_read_b64_tr_b16 v[72:73], v52 offset:8192
    v_mfma_f32_16x16x32_bf16 v[28:31], v[76:79], v[172:175], v[28:31]
    ds_read_b64_tr_b16 v[74:75], v52 offset:10240
    v_mfma_f32_16x16x32_bf16 v[32:35], v[76:79], v[204:207], v[32:35]
    v_cvt_pk_bf16_f32 v43, v6, v7
    v_mfma_f32_16x16x32_bf16 v[36:39], v[76:79], v[236:239], v[36:39]
    buffer_store_dwordx4 v[40:43], v53, s[28:31], s58 offen sc1
    s_waitcnt lgkmcnt(12)
    v_mfma_f32_16x16x32_bf16 v[20:23], v[80:83], v[112:115], v[20:23]
    s_add_u32 s58, s58, 65536
    v_mfma_f32_16x16x32_bf16 v[24:27], v[80:83], v[144:147], v[24:27]
    ds_read_b64_tr_b16 v[76:77], v52 offset:12288
    v_mfma_f32_16x16x32_bf16 v[28:31], v[80:83], v[176:179], v[28:31]
    ds_read_b64_tr_b16 v[78:79], v52 offset:14336
    v_mfma_f32_16x16x32_bf16 v[32:35], v[80:83], v[208:211], v[32:35]
    v_cvt_pk_bf16_f32 v44, v12, v13
    v_mfma_f32_16x16x32_bf16 v[36:39], v[80:83], v[240:243], v[36:39]
    v_cvt_pk_bf16_f32 v45, v14, v15
    s_waitcnt lgkmcnt(12)
    v_mfma_f32_16x16x32_bf16 v[20:23], v[84:87], v[116:119], v[20:23]
    v_cvt_pk_bf16_f32 v46, v16, v17
    v_mfma_f32_16x16x32_bf16 v[24:27], v[84:87], v[148:151], v[24:27]
    ds_read_b64_tr_b16 v[80:81], v52 offset:16384
    v_mfma_f32_16x16x32_bf16 v[28:31], v[84:87], v[180:183], v[28:31]
    ds_read_b64_tr_b16 v[82:83], v52 offset:18432
    v_mfma_f32_16x16x32_bf16 v[32:35], v[84:87], v[212:215], v[32:35]
    v_cvt_pk_bf16_f32 v47, v18, v19
    v_mfma_f32_16x16x32_bf16 v[36:39], v[84:87], v[244:247], v[36:39]
    buffer_store_dwordx4 v[44:47], v53, s[28:31], s58 offen sc1
    s_waitcnt lgkmcnt(12)
    v_mfma_f32_16x16x32_bf16 v[20:23], v[88:91], v[120:123], v[20:23]
    s_add_u32 s58, s58, 65536
    v_mfma_f32_16x16x32_bf16 v[24:27], v[88:91], v[152:155], v[24:27]
    ds_read_b64_tr_b16 v[84:85], v52 offset:20480
    v_mfma_f32_16x16x32_bf16 v[28:31], v[88:91], v[184:187], v[28:31]
    ds_read_b64_tr_b16 v[86:87], v52 offset:22528
    v_mfma_f32_16x16x32_bf16 v[32:35], v[88:91], v[216:219], v[32:35]
    v_cvt_pk_bf16_f32 v48, v8, v9
    v_mfma_f32_16x16x32_bf16 v[36:39], v[88:91], v[248:251], v[36:39]
    v_cvt_pk_bf16_f32 v49, v10, v11
    s_waitcnt lgkmcnt(12)
    v_mfma_f32_16x16x32_bf16 v[20:23], v[92:95], v[124:127], v[20:23]
    v_mfma_f32_16x16x32_bf16 v[24:27], v[92:95], v[156:159], v[24:27]
    ds_read_b64_tr_b16 v[88:89], v52 offset:24576
    v_mfma_f32_16x16x32_bf16 v[28:31], v[92:95], v[188:191], v[28:31]
    ds_read_b64_tr_b16 v[90:91], v52 offset:26624
    v_mfma_f32_16x16x32_bf16 v[32:35], v[92:95], v[220:223], v[32:35]
    v_mfma_f32_16x16x32_bf16 v[36:39], v[92:95], v[252:255], v[36:39]
    ds_read_b64_tr_b16 v[92:93], v52 offset:28672
    ds_read_b64_tr_b16 v[94:95], v52 offset:30720
    v_add_u32 v52, 0x8000, v52
    s_waitcnt lgkmcnt(14)
    v_mfma_f32_16x16x32_bf16 v[0:3], v[64:67], v[96:99], 0
    v_mfma_f32_16x16x32_bf16 v[4:7], v[64:67], v[128:131], 0
    v_mfma_f32_16x16x32_bf16 v[8:11], v[64:67], v[160:163], 0
    v_mfma_f32_16x16x32_bf16 v[12:15], v[64:67], v[192:195], 0
    v_mfma_f32_16x16x32_bf16 v[16:19], v[64:67], v[224:227], 0
    s_barrier
    s_waitcnt lgkmcnt(12)
    v_mfma_f32_16x16x32_bf16 v[0:3], v[68:71], v[100:103], v[0:3]
    v_mfma_f32_16x16x32_bf16 v[4:7], v[68:71], v[132:135], v[4:7]
    ds_read_b64_tr_b16 v[64:65], v52 offset:0
    v_mfma_f32_16x16x32_bf16 v[8:11], v[68:71], v[164:167], v[8:11]
    ds_read_b64_tr_b16 v[66:67], v52 offset:2048
    v_mfma_f32_16x16x32_bf16 v[12:15], v[68:71], v[196:199], v[12:15]
    v_mfma_f32_16x16x32_bf16 v[16:19], v[68:71], v[228:231], v[16:19]
    s_waitcnt lgkmcnt(12)
    v_mfma_f32_16x16x32_bf16 v[0:3], v[72:75], v[104:107], v[0:3]
    v_cvt_pk_bf16_f32 v40, v20, v21
    v_mfma_f32_16x16x32_bf16 v[4:7], v[72:75], v[136:139], v[4:7]
    ds_read_b64_tr_b16 v[68:69], v52 offset:4096
    v_mfma_f32_16x16x32_bf16 v[8:11], v[72:75], v[168:171], v[8:11]
    ds_read_b64_tr_b16 v[70:71], v52 offset:6144
    v_mfma_f32_16x16x32_bf16 v[12:15], v[72:75], v[200:203], v[12:15]
    v_cvt_pk_bf16_f32 v41, v22, v23
    v_mfma_f32_16x16x32_bf16 v[16:19], v[72:75], v[232:235], v[16:19]
    v_cvt_pk_bf16_f32 v42, v24, v25
    s_waitcnt lgkmcnt(12)
    v_mfma_f32_16x16x32_bf16 v[0:3], v[76:79], v[108:111], v[0:3]
    v_cvt_pk_bf16_f32 v43, v26, v27
    v_mfma_f32_16x16x32_bf16 v[4:7], v[76:79], v[140:143], v[4:7]
    ds_read_b64_tr_b16 v[72:73], v52 offset:8192
    v_mfma_f32_16x16x32_bf16 v[8:11], v[76:79], v[172:175], v[8:11]
    ds_read_b64_tr_b16 v[74:75], v52 offset:10240
    v_mfma_f32_16x16x32_bf16 v[12:15], v[76:79], v[204:207], v[12:15]
    buffer_store_dwordx4 v[40:43], v53, s[28:31], s58 offen sc1
    v_mfma_f32_16x16x32_bf16 v[16:19], v[76:79], v[236:239], v[16:19]
    s_add_u32 s58, s58, 65536
    s_waitcnt lgkmcnt(12)
    v_mfma_f32_16x16x32_bf16 v[0:3], v[80:83], v[112:115], v[0:3]
    v_cvt_pk_bf16_f32 v44, v32, v33
    v_mfma_f32_16x16x32_bf16 v[4:7], v[80:83], v[144:147], v[4:7]
    ds_read_b64_tr_b16 v[76:77], v52 offset:12288
    v_mfma_f32_16x16x32_bf16 v[8:11], v[80:83], v[176:179], v[8:11]
    ds_read_b64_tr_b16 v[78:79], v52 offset:14336
    v_mfma_f32_16x16x32_bf16 v[12:15], v[80:83], v[208:211], v[12:15]
    v_cvt_pk_bf16_f32 v45, v34, v35
    v_mfma_f32_16x16x32_bf16 v[16:19], v[80:83], v[240:243], v[16:19]
    v_cvt_pk_bf16_f32 v46, v36, v37
    s_waitcnt lgkmcnt(12)
    v_mfma_f32_16x16x32_bf16 v[0:3], v[84:87], v[116:119], v[0:3]
    v_cvt_pk_bf16_f32 v47, v38, v39
    v_mfma_f32_16x16x32_bf16 v[4:7], v[84:87], v[148:151], v[4:7]
    ds_read_b64_tr_b16 v[80:81], v52 offset:16384
    v_mfma_f32_16x16x32_bf16 v[8:11], v[84:87], v[180:183], v[8:11]
    ds_read_b64_tr_b16 v[82:83], v52 offset:18432
    v_mfma_f32_16x16x32_bf16 v[12:15], v[84:87], v[212:215], v[12:15]
    buffer_store_dwordx4 v[44:47], v53, s[28:31], s58 offen sc1
    v_mfma_f32_16x16x32_bf16 v[16:19], v[84:87], v[244:247], v[16:19]
    s_add_u32 s58, s58, 65536
    s_waitcnt lgkmcnt(12)
    v_mfma_f32_16x16x32_bf16 v[0:3], v[88:91], v[120:123], v[0:3]
    v_cvt_pk_bf16_f32 v50, v28, v29
    v_mfma_f32_16x16x32_bf16 v[4:7], v[88:91], v[152:155], v[4:7]
    ds_read_b64_tr_b16 v[84:85], v52 offset:20480
    v_mfma_f32_16x16x32_bf16 v[8:11], v[88:91], v[184:187], v[8:11]
    ds_read_b64_tr_b16 v[86:87], v52 offset:22528
    v_mfma_f32_16x16x32_bf16 v[12:15], v[88:91], v[216:219], v[12:15]
    v_cvt_pk_bf16_f32 v51, v30, v31
    v_mfma_f32_16x16x32_bf16 v[16:19], v[88:91], v[248:251], v[16:19]
    buffer_store_dwordx4 v[48:51], v53, s[28:31], s58 offen sc1
    s_waitcnt lgkmcnt(12)
    v_mfma_f32_16x16x32_bf16 v[0:3], v[92:95], v[124:127], v[0:3]
    s_add_u32 s58, s58, 65536
    v_mfma_f32_16x16x32_bf16 v[4:7], v[92:95], v[156:159], v[4:7]
    ds_read_b64_tr_b16 v[88:89], v52 offset:24576
    v_mfma_f32_16x16x32_bf16 v[8:11], v[92:95], v[188:191], v[8:11]
    ds_read_b64_tr_b16 v[90:91], v52 offset:26624
    v_mfma_f32_16x16x32_bf16 v[12:15], v[92:95], v[220:223], v[12:15]
    v_mfma_f32_16x16x32_bf16 v[16:19], v[92:95], v[252:255], v[16:19]
    ds_read_b64_tr_b16 v[92:93], v52 offset:28672
    ds_read_b64_tr_b16 v[94:95], v52 offset:30720
    v_add_u32 v52, 0x8000, v52
    s_waitcnt lgkmcnt(14)
    v_mfma_f32_16x16x32_bf16 v[20:23], v[64:67], v[96:99], 0
    v_mfma_f32_16x16x32_bf16 v[24:27], v[64:67], v[128:131], 0
    v_mfma_f32_16x16x32_bf16 v[28:31], v[64:67], v[160:163], 0
    v_mfma_f32_16x16x32_bf16 v[32:35], v[64:67], v[192:195], 0
    v_mfma_f32_16x16x32_bf16 v[36:39], v[64:67], v[224:227], 0
    s_barrier
    s_waitcnt lgkmcnt(12)
    v_mfma_f32_16x16x32_bf16 v[20:23], v[68:71], v[100:103], v[20:23]
    v_mfma_f32_16x16x32_bf16 v[24:27], v[68:71], v[132:135], v[24:27]
    ds_read_b64_tr_b16 v[64:65], v52 offset:0
    v_mfma_f32_16x16x32_bf16 v[28:31], v[68:71], v[164:167], v[28:31]
    ds_read_b64_tr_b16 v[66:67], v52 offset:2048
    v_mfma_f32_16x16x32_bf16 v[32:35], v[68:71], v[196:199], v[32:35]
    v_mfma_f32_16x16x32_bf16 v[36:39], v[68:71], v[228:231], v[36:39]
    s_waitcnt lgkmcnt(12)
    v_mfma_f32_16x16x32_bf16 v[20:23], v[72:75], v[104:107], v[20:23]
    s_waitcnt vmcnt(6)
    buffer_store_dwordx2 v[54:55], v56, s[28:31], s45 offen offset:512 sc1
    v_mfma_f32_16x16x32_bf16 v[24:27], v[72:75], v[136:139], v[24:27]
    ds_read_b64_tr_b16 v[68:69], v52 offset:4096
    v_mfma_f32_16x16x32_bf16 v[28:31], v[72:75], v[168:171], v[28:31]
    ds_read_b64_tr_b16 v[70:71], v52 offset:6144
    v_mfma_f32_16x16x32_bf16 v[32:35], v[72:75], v[200:203], v[32:35]
    v_cvt_pk_bf16_f32 v40, v0, v1
    v_mfma_f32_16x16x32_bf16 v[36:39], v[72:75], v[232:235], v[36:39]
    v_cvt_pk_bf16_f32 v41, v2, v3
    s_waitcnt lgkmcnt(12)
    v_mfma_f32_16x16x32_bf16 v[20:23], v[76:79], v[108:111], v[20:23]
    v_cvt_pk_bf16_f32 v42, v4, v5
    v_mfma_f32_16x16x32_bf16 v[24:27], v[76:79], v[140:143], v[24:27]
    ds_read_b64_tr_b16 v[72:73], v52 offset:8192
    v_mfma_f32_16x16x32_bf16 v[28:31], v[76:79], v[172:175], v[28:31]
    ds_read_b64_tr_b16 v[74:75], v52 offset:10240
    v_mfma_f32_16x16x32_bf16 v[32:35], v[76:79], v[204:207], v[32:35]
    v_cvt_pk_bf16_f32 v43, v6, v7
    v_mfma_f32_16x16x32_bf16 v[36:39], v[76:79], v[236:239], v[36:39]
    buffer_store_dwordx4 v[40:43], v53, s[28:31], s58 offen sc1
    s_waitcnt lgkmcnt(12)
    v_mfma_f32_16x16x32_bf16 v[20:23], v[80:83], v[112:115], v[20:23]
    s_add_u32 s58, s58, 65536
    v_mfma_f32_16x16x32_bf16 v[24:27], v[80:83], v[144:147], v[24:27]
    ds_read_b64_tr_b16 v[76:77], v52 offset:12288
    v_mfma_f32_16x16x32_bf16 v[28:31], v[80:83], v[176:179], v[28:31]
    ds_read_b64_tr_b16 v[78:79], v52 offset:14336
    v_mfma_f32_16x16x32_bf16 v[32:35], v[80:83], v[208:211], v[32:35]
    v_cvt_pk_bf16_f32 v44, v12, v13
    v_mfma_f32_16x16x32_bf16 v[36:39], v[80:83], v[240:243], v[36:39]
    v_cvt_pk_bf16_f32 v45, v14, v15
    s_waitcnt lgkmcnt(12)
    v_mfma_f32_16x16x32_bf16 v[20:23], v[84:87], v[116:119], v[20:23]
    v_cvt_pk_bf16_f32 v46, v16, v17
    v_mfma_f32_16x16x32_bf16 v[24:27], v[84:87], v[148:151], v[24:27]
    ds_read_b64_tr_b16 v[80:81], v52 offset:16384
    v_mfma_f32_16x16x32_bf16 v[28:31], v[84:87], v[180:183], v[28:31]
    ds_read_b64_tr_b16 v[82:83], v52 offset:18432
    v_mfma_f32_16x16x32_bf16 v[32:35], v[84:87], v[212:215], v[32:35]
    v_cvt_pk_bf16_f32 v47, v18, v19
    v_mfma_f32_16x16x32_bf16 v[36:39], v[84:87], v[244:247], v[36:39]
    buffer_store_dwordx4 v[44:47], v53, s[28:31], s58 offen sc1
    s_waitcnt lgkmcnt(12)
    v_mfma_f32_16x16x32_bf16 v[20:23], v[88:91], v[120:123], v[20:23]
    s_add_u32 s58, s58, 65536
    v_mfma_f32_16x16x32_bf16 v[24:27], v[88:91], v[152:155], v[24:27]
    ds_read_b64_tr_b16 v[84:85], v52 offset:20480
    v_mfma_f32_16x16x32_bf16 v[28:31], v[88:91], v[184:187], v[28:31]
    ds_read_b64_tr_b16 v[86:87], v52 offset:22528
    v_mfma_f32_16x16x32_bf16 v[32:35], v[88:91], v[216:219], v[32:35]
    v_cvt_pk_bf16_f32 v48, v8, v9
    v_mfma_f32_16x16x32_bf16 v[36:39], v[88:91], v[248:251], v[36:39]
    v_cvt_pk_bf16_f32 v49, v10, v11
    s_waitcnt lgkmcnt(12)
    v_mfma_f32_16x16x32_bf16 v[20:23], v[92:95], v[124:127], v[20:23]
    v_mfma_f32_16x16x32_bf16 v[24:27], v[92:95], v[156:159], v[24:27]
    ds_read_b64_tr_b16 v[88:89], v52 offset:24576
    v_mfma_f32_16x16x32_bf16 v[28:31], v[92:95], v[188:191], v[28:31]
    ds_read_b64_tr_b16 v[90:91], v52 offset:26624
    v_mfma_f32_16x16x32_bf16 v[32:35], v[92:95], v[220:223], v[32:35]
    v_mfma_f32_16x16x32_bf16 v[36:39], v[92:95], v[252:255], v[36:39]
    ds_read_b64_tr_b16 v[92:93], v52 offset:28672
    ds_read_b64_tr_b16 v[94:95], v52 offset:30720
    s_waitcnt lgkmcnt(14)
    v_mfma_f32_16x16x32_bf16 v[0:3], v[64:67], v[96:99], 0
    v_mfma_f32_16x16x32_bf16 v[4:7], v[64:67], v[128:131], 0
    v_mfma_f32_16x16x32_bf16 v[8:11], v[64:67], v[160:163], 0
    v_mfma_f32_16x16x32_bf16 v[12:15], v[64:67], v[192:195], 0
    v_mfma_f32_16x16x32_bf16 v[16:19], v[64:67], v[224:227], 0
    s_waitcnt lgkmcnt(12)
    v_mfma_f32_16x16x32_bf16 v[0:3], v[68:71], v[100:103], v[0:3]
    v_mfma_f32_16x16x32_bf16 v[4:7], v[68:71], v[132:135], v[4:7]
    v_mfma_f32_16x16x32_bf16 v[8:11], v[68:71], v[164:167], v[8:11]
    v_mfma_f32_16x16x32_bf16 v[12:15], v[68:71], v[196:199], v[12:15]
    v_mfma_f32_16x16x32_bf16 v[16:19], v[68:71], v[228:231], v[16:19]
    s_waitcnt lgkmcnt(10)
    v_mfma_f32_16x16x32_bf16 v[0:3], v[72:75], v[104:107], v[0:3]
    v_cvt_pk_bf16_f32 v40, v20, v21
    v_mfma_f32_16x16x32_bf16 v[4:7], v[72:75], v[136:139], v[4:7]
    v_mfma_f32_16x16x32_bf16 v[8:11], v[72:75], v[168:171], v[8:11]
    v_mfma_f32_16x16x32_bf16 v[12:15], v[72:75], v[200:203], v[12:15]
    v_cvt_pk_bf16_f32 v41, v22, v23
    v_mfma_f32_16x16x32_bf16 v[16:19], v[72:75], v[232:235], v[16:19]
    v_cvt_pk_bf16_f32 v42, v24, v25
    s_waitcnt lgkmcnt(8)
    v_mfma_f32_16x16x32_bf16 v[0:3], v[76:79], v[108:111], v[0:3]
    v_cvt_pk_bf16_f32 v43, v26, v27
    v_mfma_f32_16x16x32_bf16 v[4:7], v[76:79], v[140:143], v[4:7]
    v_mfma_f32_16x16x32_bf16 v[8:11], v[76:79], v[172:175], v[8:11]
    v_mfma_f32_16x16x32_bf16 v[12:15], v[76:79], v[204:207], v[12:15]
    buffer_store_dwordx4 v[40:43], v53, s[28:31], s58 offen sc1
    v_mfma_f32_16x16x32_bf16 v[16:19], v[76:79], v[236:239], v[16:19]
    s_add_u32 s58, s58, 65536
    s_waitcnt lgkmcnt(6)
    v_mfma_f32_16x16x32_bf16 v[0:3], v[80:83], v[112:115], v[0:3]
    v_cvt_pk_bf16_f32 v44, v32, v33
    v_mfma_f32_16x16x32_bf16 v[4:7], v[80:83], v[144:147], v[4:7]
    v_mfma_f32_16x16x32_bf16 v[8:11], v[80:83], v[176:179], v[8:11]
    v_mfma_f32_16x16x32_bf16 v[12:15], v[80:83], v[208:211], v[12:15]
    v_cvt_pk_bf16_f32 v45, v34, v35
    v_mfma_f32_16x16x32_bf16 v[16:19], v[80:83], v[240:243], v[16:19]
    v_cvt_pk_bf16_f32 v46, v36, v37
    s_waitcnt lgkmcnt(4)
    v_mfma_f32_16x16x32_bf16 v[0:3], v[84:87], v[116:119], v[0:3]
    v_cvt_pk_bf16_f32 v47, v38, v39
    v_mfma_f32_16x16x32_bf16 v[4:7], v[84:87], v[148:151], v[4:7]
    v_mfma_f32_16x16x32_bf16 v[8:11], v[84:87], v[180:183], v[8:11]
    v_mfma_f32_16x16x32_bf16 v[12:15], v[84:87], v[212:215], v[12:15]
    buffer_store_dwordx4 v[44:47], v53, s[28:31], s58 offen sc1
    v_mfma_f32_16x16x32_bf16 v[16:19], v[84:87], v[244:247], v[16:19]
    s_add_u32 s58, s58, 65536
    s_waitcnt lgkmcnt(2)
    v_mfma_f32_16x16x32_bf16 v[0:3], v[88:91], v[120:123], v[0:3]
    v_cvt_pk_bf16_f32 v50, v28, v29
    v_mfma_f32_16x16x32_bf16 v[4:7], v[88:91], v[152:155], v[4:7]
    v_mfma_f32_16x16x32_bf16 v[8:11], v[88:91], v[184:187], v[8:11]
    v_mfma_f32_16x16x32_bf16 v[12:15], v[88:91], v[216:219], v[12:15]
    v_cvt_pk_bf16_f32 v51, v30, v31
    v_mfma_f32_16x16x32_bf16 v[16:19], v[88:91], v[248:251], v[16:19]
    buffer_store_dwordx4 v[48:51], v53, s[28:31], s58 offen sc1
    s_waitcnt lgkmcnt(0)
    v_mfma_f32_16x16x32_bf16 v[0:3], v[92:95], v[124:127], v[0:3]
    s_add_u32 s58, s58, 65536
    v_mfma_f32_16x16x32_bf16 v[4:7], v[92:95], v[156:159], v[4:7]
    v_mfma_f32_16x16x32_bf16 v[8:11], v[92:95], v[188:191], v[8:11]
    v_mfma_f32_16x16x32_bf16 v[12:15], v[92:95], v[220:223], v[12:15]
    v_mfma_f32_16x16x32_bf16 v[16:19], v[92:95], v[252:255], v[16:19]
    s_barrier
    s_nop 7
    v_cvt_pk_bf16_f32 v40, v0, v1
    v_cvt_pk_bf16_f32 v41, v2, v3
    v_cvt_pk_bf16_f32 v42, v4, v5
    v_cvt_pk_bf16_f32 v43, v6, v7
    buffer_store_dwordx4 v[40:43], v53, s[28:31], s58 offen sc1
    s_add_u32 s58, s58, 65536
    v_cvt_pk_bf16_f32 v44, v12, v13
    v_cvt_pk_bf16_f32 v45, v14, v15
    v_cvt_pk_bf16_f32 v46, v16, v17
    v_cvt_pk_bf16_f32 v47, v18, v19
    buffer_store_dwordx4 v[44:47], v53, s[28:31], s58 offen sc1
    s_add_u32 s58, s58, 65536
    v_cvt_pk_bf16_f32 v48, v8, v9
    v_cvt_pk_bf16_f32 v49, v10, v11
    buffer_store_dwordx4 v[48:51], v53, s[28:31], s58 offen sc1
    s_add_u32 s58, s58, 65536
    s_waitcnt vmcnt(9)
    buffer_store_dwordx2 v[54:55], v56, s[28:31], s45 offen offset:1024 sc1
    s_waitcnt vmcnt(4)
    buffer_store_dwordx2 v[54:55], v56, s[28:31], s45 offen offset:1536 sc1
    s_waitcnt vmcnt(2)
    buffer_store_dwordx2 v[54:55], v56, s[28:31], s45 offen offset:2048 sc1
    s_lshl_b32 s44, s49, 4
    s_add_u32 s44, s44, s36
    s_add_u32 s44, s44, 60
    v_mov_b32 v0, v57
    v_mov_b32 v4, v54
    v_mov_b32 v5, v55
    s_cmp_ge_u32 s44, 92
    s_cbranch_scc1 L_done
L_reduce:
    s_mul_i32 s50, s44, 205
    s_lshr_b32 s50, s50, 12
    s_and_b32 s42, s44, 3
    s_mul_i32 s39, s37, 5
    s_add_u32 s39, s39, s50
    s_lshl_b32 s39, s39, 2
    s_add_u32 s39, s39, s42
    s_lshl_b32 s39, s39, 7
    s_add_u32 s45, s39, 100663296
    v_and_b32 v2, 15, v0
    v_lshlrev_b32 v8, 3, v2
    buffer_load_dwordx2 v[6:7], v8, s[28:31], s45 offen sc1
    s_mul_i32 s39, s50, 20
    s_sub_u32 s51, s44, s39
    s_lshr_b32 s51, s51, 2
    s_cmp_ge_u32 s44, 88
    s_cselect_b32 s51, 4, s51
    s_mov_b32 s54, 128
    s_cselect_b32 s54, 0x10000000, s54
    s_and_b32 s39, s51, 1
    s_mul_i32 s52, s39, 55296
    s_and_b32 s39, s51, 2
    s_lshl_b32 s39, s39, 6
    s_add_u32 s52, s52, s39
    s_cmp_eq_u32 s51, 4
    s_cselect_b32 s52, 36864, s52
    s_cselect_b32 s54, s54, 18432
    s_lshl_b32 s39, s50, 8
    s_add_u32 s52, s52, s39
    s_lshl_b32 s39, s42, 5
    s_add_u32 s52, s52, s39
    s_mul_i32 s39, s37, 92160
    s_add_u32 s52, s52, s39
    s_add_u32 s53, s52, s54
    s_mul_i32 s58, s37, 96
    s_add_u32 s58, s58, s44
    s_lshl_b32 s58, s58, 14
    v_lshlrev_b32 v1, 4, v0
    v_lshrrev_b32 v3, 4, v0
    v_mul_u32_u24 v2, 1152, v2
    v_lshl_add_u32 v2, v3, 3, v2
    v_bfe_u32 v9, v0, 2, 2
    v_and_b32 v10, 1, v0
    v_lshlrev_b32 v10, 4, v10
    v_mov_b32 v11, 0x3f80
    v_lshlrev_b32 v10, v10, v11
    v_cmp_eq_u32 vcc, v9, v3
    v_mov_b32 v24, 0
    v_mov_b32 v25, 0
    v_cndmask_b32 v10, 0, v10, vcc
    v_and_b32 v9, 2, v0
    v_cmp_eq_u32 vcc, 0, v9
    v_mov_b32 v28, 0
    v_mov_b32 v29, 0
    v_cndmask_b32 v26, 0, v10, vcc
    v_sub_u32 v27, v10, v26
    s_mov_b32 s43, 0
L_poll:
    s_waitcnt vmcnt(0)
    v_cmp_ne_u64 vcc, v[6:7], v[4:5]
    s_cbranch_vccz L_ready
    buffer_load_dwordx2 v[6:7], v8, s[28:31], s45 offen sc1
    s_add_u32 s43, s43, 1
    s_cmp_lt_u32 s43, 0x200000
    s_cbranch_scc1 L_poll
L_ready:
    buffer_load_dwordx4 v[64:67], v1, s[28:31], s58 offen offset:0 sc1
    buffer_load_dwordx4 v[68:71], v1, s[28:31], s58 offen offset:1024 sc1
    buffer_load_dwordx4 v[72:75], v1, s[28:31], s58 offen offset:2048 sc1
    buffer_load_dwordx4 v[76:79], v1, s[28:31], s58 offen offset:3072 sc1
    s_add_u32 s58, s58, 4096
    buffer_load_dwordx4 v[80:83], v1, s[28:31], s58 offen offset:0 sc1
    buffer_load_dwordx4 v[84:87], v1, s[28:31], s58 offen offset:1024 sc1
    buffer_load_dwordx4 v[88:91], v1, s[28:31], s58 offen offset:2048 sc1
    buffer_load_dwordx4 v[92:95], v1, s[28:31], s58 offen offset:3072 sc1
    s_add_u32 s58, s58, 4096
    buffer_load_dwordx4 v[96:99], v1, s[28:31], s58 offen offset:0 sc1
    buffer_load_dwordx4 v[100:103], v1, s[28:31], s58 offen offset:1024 sc1
    buffer_load_dwordx4 v[104:107], v1, s[28:31], s58 offen offset:2048 sc1
    buffer_load_dwordx4 v[108:111], v1, s[28:31], s58 offen offset:3072 sc1
    s_add_u32 s58, s58, 4096
    buffer_load_dwordx4 v[112:115], v1, s[28:31], s58 offen offset:0 sc1
    buffer_load_dwordx4 v[116:119], v1, s[28:31], s58 offen offset:1024 sc1
    buffer_load_dwordx4 v[120:123], v1, s[28:31], s58 offen offset:2048 sc1
    buffer_load_dwordx4 v[124:127], v1, s[28:31], s58 offen offset:3072 sc1
    s_waitcnt vmcnt(15)
    v_mfma_f32_16x16x32_bf16 v[16:19], v[26:29], v[64:67], 0
    v_mfma_f32_16x16x32_bf16 v[20:23], v[24:27], v[64:67], 0
    s_waitcnt vmcnt(14)
    v_mfma_f32_16x16x32_bf16 v[16:19], v[26:29], v[68:71], v[16:19]
    v_mfma_f32_16x16x32_bf16 v[20:23], v[24:27], v[68:71], v[20:23]
    s_waitcnt vmcnt(13)
    v_mfma_f32_16x16x32_bf16 v[16:19], v[26:29], v[72:75], v[16:19]
    v_mfma_f32_16x16x32_bf16 v[20:23], v[24:27], v[72:75], v[20:23]
    s_waitcnt vmcnt(12)
    v_mfma_f32_16x16x32_bf16 v[16:19], v[26:29], v[76:79], v[16:19]
    v_mfma_f32_16x16x32_bf16 v[20:23], v[24:27], v[76:79], v[20:23]
    s_waitcnt vmcnt(11)
    v_mfma_f32_16x16x32_bf16 v[16:19], v[26:29], v[80:83], v[16:19]
    v_mfma_f32_16x16x32_bf16 v[20:23], v[24:27], v[80:83], v[20:23]
    s_waitcnt vmcnt(10)
    v_mfma_f32_16x16x32_bf16 v[16:19], v[26:29], v[84:87], v[16:19]
    v_mfma_f32_16x16x32_bf16 v[20:23], v[24:27], v[84:87], v[20:23]
    s_waitcnt vmcnt(9)
    v_mfma_f32_16x16x32_bf16 v[16:19], v[26:29], v[88:91], v[16:19]
    v_mfma_f32_16x16x32_bf16 v[20:23], v[24:27], v[88:91], v[20:23]
    s_waitcnt vmcnt(8)
    v_mfma_f32_16x16x32_bf16 v[16:19], v[26:29], v[92:95], v[16:19]
    v_mfma_f32_16x16x32_bf16 v[20:23], v[24:27], v[92:95], v[20:23]
    s_waitcnt vmcnt(7)
    v_mfma_f32_16x16x32_bf16 v[16:19], v[26:29], v[96:99], v[16:19]
    v_mfma_f32_16x16x32_bf16 v[20:23], v[24:27], v[96:99], v[20:23]
    s_waitcnt vmcnt(6)
    v_mfma_f32_16x16x32_bf16 v[16:19], v[26:29], v[100:103], v[16:19]
    v_mfma_f32_16x16x32_bf16 v[20:23], v[24:27], v[100:103], v[20:23]
    s_waitcnt vmcnt(5)
    v_mfma_f32_16x16x32_bf16 v[16:19], v[26:29], v[104:107], v[16:19]
    v_mfma_f32_16x16x32_bf16 v[20:23], v[24:27], v[104:107], v[20:23]
    s_waitcnt vmcnt(4)
    v_mfma_f32_16x16x32_bf16 v[16:19], v[26:29], v[108:111], v[16:19]
    v_mfma_f32_16x16x32_bf16 v[20:23], v[24:27], v[108:111], v[20:23]
    s_waitcnt vmcnt(3)
    v_mfma_f32_16x16x32_bf16 v[16:19], v[26:29], v[112:115], v[16:19]
    v_mfma_f32_16x16x32_bf16 v[20:23], v[24:27], v[112:115], v[20:23]
    s_waitcnt vmcnt(2)
    v_mfma_f32_16x16x32_bf16 v[16:19], v[26:29], v[116:119], v[16:19]
    v_mfma_f32_16x16x32_bf16 v[20:23], v[24:27], v[116:119], v[20:23]
    s_waitcnt vmcnt(1)
    v_mfma_f32_16x16x32_bf16 v[16:19], v[26:29], v[120:123], v[16:19]
    v_mfma_f32_16x16x32_bf16 v[20:23], v[24:27], v[120:123], v[20:23]
    s_waitcnt vmcnt(0)
    v_mfma_f32_16x16x32_bf16 v[16:19], v[26:29], v[124:127], v[16:19]
    v_mfma_f32_16x16x32_bf16 v[20:23], v[24:27], v[124:127], v[20:23]
    s_nop 7
    v_cvt_pk_bf16_f32 v12, v16, v17
    v_cvt_pk_bf16_f32 v13, v18, v19
    v_cvt_pk_bf16_f32 v14, v20, v21
    v_cvt_pk_bf16_f32 v15, v22, v23
    buffer_store_dwordx2 v[12:13], v2, s[32:35], s52 offen
    buffer_store_dwordx2 v[14:15], v2, s[32:35], s53 offen
L_done:
L_end:
    s_endpgm
L_tr0:
    s_call_b64 s[6:7], L_hrare1
    s_branch L_bk0
L_tr1:
    s_call_b64 s[6:7], L_hrare0
    s_branch L_bk1
L_tr2:
    s_call_b64 s[6:7], L_hrare0
    s_branch L_bk2
L_tr3:
    s_call_b64 s[6:7], L_hrare1
    s_branch L_bk3
L_tr4:
    s_call_b64 s[6:7], L_hrare0
    s_branch L_bk4
L_tr5:
    s_call_b64 s[6:7], L_hrare1
    s_branch L_bk5
L_tr6:
    s_call_b64 s[6:7], L_hrare0
    s_branch L_bk6
L_tr7:
    s_call_b64 s[6:7], L_hrare1
    s_branch L_bk7
L_tr8:
    s_call_b64 s[6:7], L_hrare0
    s_branch L_bk8
L_tr9:
    s_call_b64 s[6:7], L_hrare2
    s_branch L_bk9
L_hrare0:
    s_nop 7
    s_nop 7
    v_max3_f32 v222, v112, v113, v114
    v_max3_f32 v222, v222, v115, v116
    v_max3_f32 v222, v222, v117, v118
    v_max_f32 v222, v222, v119
    v_max3_f32 v201, v120, v121, v122
    v_max3_f32 v201, v201, v123, v124
    v_max3_f32 v201, v201, v125, v126
    v_max_f32 v201, v201, v127
    v_mov_b32 v223, v222
    v_mov_b32 v202, v201
    s_nop 1
    v_permlane16_swap_b32 v222, v223
    v_permlane16_swap_b32 v201, v202
    s_nop 1
    v_max_f32 v222, v222, v223
    v_max_f32 v201, v201, v202
    v_mov_b32 v223, v222
    v_mov_b32 v202, v201
    s_nop 1
    v_permlane32_swap_b32 v222, v223
    v_permlane32_swap_b32 v201, v202
    s_nop 1
    v_max_f32 v222, v222, v223
    v_max_f32 v201, v201, v202
    v_add_f32 v222, 0x41800000, v222
    v_add_f32 v201, 0x41800000, v201
    v_max_f32 v222, 0, v222
    v_max_f32 v201, 0, v201
    v_ceil_f32 v222, v222
    v_ceil_f32 v201, v201
    v_sub_f32 v224, 0, v222
    v_sub_f32 v225, 0, v201
    v_exp_f32 v224, v224
    v_exp_f32 v225, v225
    v_sub_f32 v112, v112, v222
    v_sub_f32 v113, v113, v222
    v_sub_f32 v114, v114, v222
    v_sub_f32 v115, v115, v222
    v_sub_f32 v116, v116, v222
    v_sub_f32 v117, v117, v222
    v_sub_f32 v118, v118, v222
    v_sub_f32 v119, v119, v222
    v_sub_f32 v120, v120, v201
    v_sub_f32 v121, v121, v201
    v_sub_f32 v122, v122, v201
    v_sub_f32 v123, v123, v201
    v_sub_f32 v124, v124, v201
    v_sub_f32 v125, v125, v201
    v_sub_f32 v126, v126, v201
    v_sub_f32 v127, v127, v201
    v_sub_f32 v128, v128, v222
    v_sub_f32 v129, v129, v222
    v_sub_f32 v130, v130, v222
    v_sub_f32 v131, v131, v222
    v_sub_f32 v132, v132, v222
    v_sub_f32 v133, v133, v222
    v_sub_f32 v134, v134, v222
    v_sub_f32 v135, v135, v222
    v_sub_f32 v136, v136, v201
    v_sub_f32 v137, v137, v201
    v_sub_f32 v138, v138, v201
    v_sub_f32 v139, v139, v201
    v_sub_f32 v140, v140, v201
    v_sub_f32 v141, v141, v201
    v_sub_f32 v142, v142, v201
    v_sub_f32 v143, v143, v201
    v_sub_f32 v96, v96, v222
    v_sub_f32 v97, v97, v222
    v_sub_f32 v98, v98, v222
    v_sub_f32 v99, v99, v222
    v_sub_f32 v100, v100, v201
    v_sub_f32 v101, v101, v201
    v_sub_f32 v102, v102, v201
    v_sub_f32 v103, v103, v201
    v_mul_f32 v0, v0, v224
    v_mul_f32 v1, v1, v224
    v_mul_f32 v2, v2, v224
    v_mul_f32 v3, v3, v224
    v_mul_f32 v4, v4, v224
    v_mul_f32 v5, v5, v224
    v_mul_f32 v6, v6, v224
    v_mul_f32 v7, v7, v224
    v_mul_f32 v8, v8, v224
    v_mul_f32 v9, v9, v224
    v_mul_f32 v10, v10, v224
    v_mul_f32 v11, v11, v224
    v_mul_f32 v12, v12, v224
    v_mul_f32 v13, v13, v224
    v_mul_f32 v14, v14, v224
    v_mul_f32 v15, v15, v224
    v_mul_f32 v16, v16, v224
    v_mul_f32 v17, v17, v224
    v_mul_f32 v18, v18, v224
    v_mul_f32 v19, v19, v224
    v_mul_f32 v20, v20, v224
    v_mul_f32 v21, v21, v224
    v_mul_f32 v22, v22, v224
    v_mul_f32 v23, v23, v224
    v_mul_f32 v24, v24, v224
    v_mul_f32 v25, v25, v224
    v_mul_f32 v26, v26, v224
    v_mul_f32 v27, v27, v224
    v_mul_f32 v28, v28, v224
    v_mul_f32 v29, v29, v224
    v_mul_f32 v30, v30, v224
    v_mul_f32 v31, v31, v224
    v_mul_f32 v32, v32, v225
    v_mul_f32 v33, v33, v225
    v_mul_f32 v34, v34, v225
    v_mul_f32 v35, v35, v225
    v_mul_f32 v36, v36, v225
    v_mul_f32 v37, v37, v225
    v_mul_f32 v38, v38, v225
    v_mul_f32 v39, v39, v225
    v_mul_f32 v40, v40, v225
    v_mul_f32 v41, v41, v225
    v_mul_f32 v42, v42, v225
    v_mul_f32 v43, v43, v225
    v_mul_f32 v44, v44, v225
    v_mul_f32 v45, v45, v225
    v_mul_f32 v46, v46, v225
    v_mul_f32 v47, v47, v225
    v_mul_f32 v48, v48, v225
    v_mul_f32 v49, v49, v225
    v_mul_f32 v50, v50, v225
    v_mul_f32 v51, v51, v225
    v_mul_f32 v52, v52, v225
    v_mul_f32 v53, v53, v225
    v_mul_f32 v54, v54, v225
    v_mul_f32 v55, v55, v225
    v_mul_f32 v56, v56, v225
    v_mul_f32 v57, v57, v225
    v_mul_f32 v58, v58, v225
    v_mul_f32 v59, v59, v225
    v_mul_f32 v60, v60, v225
    v_mul_f32 v61, v61, v225
    v_mul_f32 v62, v62, v225
    v_mul_f32 v63, v63, v225
    v_mul_f32 v104, v104, v224
    v_mul_f32 v105, v105, v224
    v_mul_f32 v106, v106, v224
    v_mul_f32 v107, v107, v224
    v_mul_f32 v108, v108, v225
    v_mul_f32 v109, v109, v225
    v_mul_f32 v110, v110, v225
    v_mul_f32 v111, v111, v225
    v_exp_f32 v192, v112
    v_exp_f32 v193, v113
    v_exp_f32 v194, v114
    v_cvt_pk_bf16_f32 v144, v192, v193
    v_exp_f32 v195, v115
    v_exp_f32 v196, v116
    v_cvt_pk_bf16_f32 v145, v194, v195
    v_exp_f32 v197, v117
    v_exp_f32 v198, v118
    v_cvt_pk_bf16_f32 v146, v196, v197
    v_exp_f32 v199, v119
    v_exp_f32 v192, v120
    v_cvt_pk_bf16_f32 v147, v198, v199
    v_exp_f32 v193, v121
    v_exp_f32 v194, v122
    v_cvt_pk_bf16_f32 v148, v192, v193
    v_exp_f32 v195, v123
    v_exp_f32 v196, v124
    v_cvt_pk_bf16_f32 v149, v194, v195
    v_exp_f32 v197, v125
    v_exp_f32 v198, v126
    v_cvt_pk_bf16_f32 v150, v196, v197
    v_exp_f32 v199, v127
    s_nop 0
    v_cvt_pk_bf16_f32 v151, v198, v199
    v_exp_f32 v192, v128
    s_nop 1
    s_setpc_b64 s[6:7]
L_hrare1:
    s_nop 7
    s_nop 7
    v_max3_f32 v222, v128, v129, v130
    v_max3_f32 v222, v222, v131, v132
    v_max3_f32 v222, v222, v133, v134
    v_max_f32 v222, v222, v135
    v_max3_f32 v201, v136, v137, v138
    v_max3_f32 v201, v201, v139, v140
    v_max3_f32 v201, v201, v141, v142
    v_max_f32 v201, v201, v143
    v_mov_b32 v223, v222
    v_mov_b32 v202, v201
    s_nop 1
    v_permlane16_swap_b32 v222, v223
    v_permlane16_swap_b32 v201, v202
    s_nop 1
    v_max_f32 v222, v222, v223
    v_max_f32 v201, v201, v202
    v_mov_b32 v223, v222
    v_mov_b32 v202, v201
    s_nop 1
    v_permlane32_swap_b32 v222, v223
    v_permlane32_swap_b32 v201, v202
    s_nop 1
    v_max_f32 v222, v222, v223
    v_max_f32 v201, v201, v202
    v_add_f32 v222, 0x41800000, v222
    v_add_f32 v201, 0x41800000, v201
    v_max_f32 v222, 0, v222
    v_max_f32 v201, 0, v201
    v_ceil_f32 v222, v222
    v_ceil_f32 v201, v201
    v_sub_f32 v224, 0, v222
    v_sub_f32 v225, 0, v201
    v_exp_f32 v224, v224
    v_exp_f32 v225, v225
    v_sub_f32 v128, v128, v222
    v_sub_f32 v129, v129, v222
    v_sub_f32 v130, v130, v222
    v_sub_f32 v131, v131, v222
    v_sub_f32 v132, v132, v222
    v_sub_f32 v133, v133, v222
    v_sub_f32 v134, v134, v222
    v_sub_f32 v135, v135, v222
    v_sub_f32 v136, v136, v201
    v_sub_f32 v137, v137, v201
    v_sub_f32 v138, v138, v201
    v_sub_f32 v139, v139, v201
    v_sub_f32 v140, v140, v201
    v_sub_f32 v141, v141, v201
    v_sub_f32 v142, v142, v201
    v_sub_f32 v143, v143, v201
    v_sub_f32 v112, v112, v222
    v_sub_f32 v113, v113, v222
    v_sub_f32 v114, v114, v222
    v_sub_f32 v115, v115, v222
    v_sub_f32 v116, v116, v222
    v_sub_f32 v117, v117, v222
    v_sub_f32 v118, v118, v222
    v_sub_f32 v119, v119, v222
    v_sub_f32 v120, v120, v201
    v_sub_f32 v121, v121, v201
    v_sub_f32 v122, v122, v201
    v_sub_f32 v123, v123, v201
    v_sub_f32 v124, v124, v201
    v_sub_f32 v125, v125, v201
    v_sub_f32 v126, v126, v201
    v_sub_f32 v127, v127, v201
    v_sub_f32 v96, v96, v222
    v_sub_f32 v97, v97, v222
    v_sub_f32 v98, v98, v222
    v_sub_f32 v99, v99, v222
    v_sub_f32 v100, v100, v201
    v_sub_f32 v101, v101, v201
    v_sub_f32 v102, v102, v201
    v_sub_f32 v103, v103, v201
    v_mul_f32 v0, v0, v224
    v_mul_f32 v1, v1, v224
    v_mul_f32 v2, v2, v224
    v_mul_f32 v3, v3, v224
    v_mul_f32 v4, v4, v224
    v_mul_f32 v5, v5, v224
    v_mul_f32 v6, v6, v224
    v_mul_f32 v7, v7, v224
    v_mul_f32 v8, v8, v224
    v_mul_f32 v9, v9, v224
    v_mul_f32 v10, v10, v224
    v_mul_f32 v11, v11, v224
    v_mul_f32 v12, v12, v224
    v_mul_f32 v13, v13, v224
    v_mul_f32 v14, v14, v224
    v_mul_f32 v15, v15, v224
    v_mul_f32 v16, v16, v224
    v_mul_f32 v17, v17, v224
    v_mul_f32 v18, v18, v224
    v_mul_f32 v19, v19, v224
    v_mul_f32 v20, v20, v224
    v_mul_f32 v21, v21, v224
    v_mul_f32 v22, v22, v224
    v_mul_f32 v23, v23, v224
    v_mul_f32 v24, v24, v224
    v_mul_f32 v25, v25, v224
    v_mul_f32 v26, v26, v224
    v_mul_f32 v27, v27, v224
    v_mul_f32 v28, v28, v224
    v_mul_f32 v29, v29, v224
    v_mul_f32 v30, v30, v224
    v_mul_f32 v31, v31, v224
    v_mul_f32 v32, v32, v225
    v_mul_f32 v33, v33, v225
    v_mul_f32 v34, v34, v225
    v_mul_f32 v35, v35, v225
    v_mul_f32 v36, v36, v225
    v_mul_f32 v37, v37, v225
    v_mul_f32 v38, v38, v225
    v_mul_f32 v39, v39, v225
    v_mul_f32 v40, v40, v225
    v_mul_f32 v41, v41, v225
    v_mul_f32 v42, v42, v225
    v_mul_f32 v43, v43, v225
    v_mul_f32 v44, v44, v225
    v_mul_f32 v45, v45, v225
    v_mul_f32 v46, v46, v225
    v_mul_f32 v47, v47, v225
    v_mul_f32 v48, v48, v225
    v_mul_f32 v49, v49, v225
    v_mul_f32 v50, v50, v225
    v_mul_f32 v51, v51, v225
    v_mul_f32 v52, v52, v225
    v_mul_f32 v53, v53, v225
    v_mul_f32 v54, v54, v225
    v_mul_f32 v55, v55, v225
    v_mul_f32 v56, v56, v225
    v_mul_f32 v57, v57, v225
    v_mul_f32 v58, v58, v225
    v_mul_f32 v59, v59, v225
    v_mul_f32 v60, v60, v225
    v_mul_f32 v61, v61, v225
    v_mul_f32 v62, v62, v225
    v_mul_f32 v63, v63, v225
    v_mul_f32 v104, v104, v224
    v_mul_f32 v105, v105, v224
    v_mul_f32 v106, v106, v224
    v_mul_f32 v107, v107, v224
    v_mul_f32 v108, v108, v225
    v_mul_f32 v109, v109, v225
    v_mul_f32 v110, v110, v225
    v_mul_f32 v111, v111, v225
    v_exp_f32 v192, v128
    v_exp_f32 v193, v129
    v_exp_f32 v194, v130
    v_cvt_pk_bf16_f32 v152, v192, v193
    v_exp_f32 v195, v131
    v_exp_f32 v196, v132
    v_cvt_pk_bf16_f32 v153, v194, v195
    v_exp_f32 v197, v133
    v_exp_f32 v198, v134
    v_cvt_pk_bf16_f32 v154, v196, v197
    v_exp_f32 v199, v135
    v_exp_f32 v192, v136
    v_cvt_pk_bf16_f32 v155, v198, v199
    v_exp_f32 v193, v137
    v_exp_f32 v194, v138
    v_cvt_pk_bf16_f32 v156, v192, v193
    v_exp_f32 v195, v139
    v_exp_f32 v196, v140
    v_cvt_pk_bf16_f32 v157, v194, v195
    v_exp_f32 v197, v141
    v_exp_f32 v198, v142
    v_cvt_pk_bf16_f32 v158, v196, v197
    v_exp_f32 v199, v143
    s_nop 0
    v_cvt_pk_bf16_f32 v159, v198, v199
    v_exp_f32 v192, v112
    s_nop 1
    s_setpc_b64 s[6:7]
L_hrare2:
    s_nop 7
    s_nop 7
    v_max3_f32 v222, v128, v129, v130
    v_max3_f32 v222, v222, v131, v132
    v_max3_f32 v222, v222, v133, v134
    v_max_f32 v222, v222, v135
    v_max3_f32 v201, v136, v137, v138
    v_max3_f32 v201, v201, v139, v140
    v_max3_f32 v201, v201, v141, v142
    v_max_f32 v201, v201, v143
    v_mov_b32 v223, v222
    v_mov_b32 v202, v201
    s_nop 1
    v_permlane16_swap_b32 v222, v223
    v_permlane16_swap_b32 v201, v202
    s_nop 1
    v_max_f32 v222, v222, v223
    v_max_f32 v201, v201, v202
    v_mov_b32 v223, v222
    v_mov_b32 v202, v201
    s_nop 1
    v_permlane32_swap_b32 v222, v223
    v_permlane32_swap_b32 v201, v202
    s_nop 1
    v_max_f32 v222, v222, v223
    v_max_f32 v201, v201, v202
    v_add_f32 v222, 0x41800000, v222
    v_add_f32 v201, 0x41800000, v201
    v_max_f32 v222, 0, v222
    v_max_f32 v201, 0, v201
    v_ceil_f32 v222, v222
    v_ceil_f32 v201, v201
    v_sub_f32 v224, 0, v222
    v_sub_f32 v225, 0, v201
    v_exp_f32 v224, v224
    v_exp_f32 v225, v225
    v_sub_f32 v128, v128, v222
    v_sub_f32 v129, v129, v222
    v_sub_f32 v130, v130, v222
    v_sub_f32 v131, v131, v222
    v_sub_f32 v132, v132, v222
    v_sub_f32 v133, v133, v222
    v_sub_f32 v134, v134, v222
    v_sub_f32 v135, v135, v222
    v_sub_f32 v136, v136, v201
    v_sub_f32 v137, v137, v201
    v_sub_f32 v138, v138, v201
    v_sub_f32 v139, v139, v201
    v_sub_f32 v140, v140, v201
    v_sub_f32 v141, v141, v201
    v_sub_f32 v142, v142, v201
    v_sub_f32 v143, v143, v201
    v_sub_f32 v112, v112, v222
    v_sub_f32 v113, v113, v222
    v_sub_f32 v114, v114, v222
    v_sub_f32 v115, v115, v222
    v_sub_f32 v116, v116, v222
    v_sub_f32 v117, v117, v222
    v_sub_f32 v118, v118, v222
    v_sub_f32 v119, v119, v222
    v_sub_f32 v120, v120, v201
    v_sub_f32 v121, v121, v201
    v_sub_f32 v122, v122, v201
    v_sub_f32 v123, v123, v201
    v_sub_f32 v124, v124, v201
    v_sub_f32 v125, v125, v201
    v_sub_f32 v126, v126, v201
    v_sub_f32 v127, v127, v201
    v_sub_f32 v96, v96, v222
    v_sub_f32 v97, v97, v222
    v_sub_f32 v98, v98, v222
    v_sub_f32 v99, v99, v222
    v_sub_f32 v100, v100, v201
    v_sub_f32 v101, v101, v201
    v_sub_f32 v102, v102, v201
    v_sub_f32 v103, v103, v201
    v_mul_f32 v0, v0, v224
    v_mul_f32 v1, v1, v224
    v_mul_f32 v2, v2, v224
    v_mul_f32 v3, v3, v224
    v_mul_f32 v4, v4, v224
    v_mul_f32 v5, v5, v224
    v_mul_f32 v6, v6, v224
    v_mul_f32 v7, v7, v224
    v_mul_f32 v8, v8, v224
    v_mul_f32 v9, v9, v224
    v_mul_f32 v10, v10, v224
    v_mul_f32 v11, v11, v224
    v_mul_f32 v12, v12, v224
    v_mul_f32 v13, v13, v224
    v_mul_f32 v14, v14, v224
    v_mul_f32 v15, v15, v224
    v_mul_f32 v16, v16, v224
    v_mul_f32 v17, v17, v224
    v_mul_f32 v18, v18, v224
    v_mul_f32 v19, v19, v224
    v_mul_f32 v20, v20, v224
    v_mul_f32 v21, v21, v224
    v_mul_f32 v22, v22, v224
    v_mul_f32 v23, v23, v224
    v_mul_f32 v24, v24, v224
    v_mul_f32 v25, v25, v224
    v_mul_f32 v26, v26, v224
    v_mul_f32 v27, v27, v224
    v_mul_f32 v28, v28, v224
    v_mul_f32 v29, v29, v224
    v_mul_f32 v30, v30, v224
    v_mul_f32 v31, v31, v224
    v_mul_f32 v32, v32, v225
    v_mul_f32 v33, v33, v225
    v_mul_f32 v34, v34, v225
    v_mul_f32 v35, v35, v225
    v_mul_f32 v36, v36, v225
    v_mul_f32 v37, v37, v225
    v_mul_f32 v38, v38, v225
    v_mul_f32 v39, v39, v225
    v_mul_f32 v40, v40, v225
    v_mul_f32 v41, v41, v225
    v_mul_f32 v42, v42, v225
    v_mul_f32 v43, v43, v225
    v_mul_f32 v44, v44, v225
    v_mul_f32 v45, v45, v225
    v_mul_f32 v46, v46, v225
    v_mul_f32 v47, v47, v225
    v_mul_f32 v48, v48, v225
    v_mul_f32 v49, v49, v225
    v_mul_f32 v50, v50, v225
    v_mul_f32 v51, v51, v225
    v_mul_f32 v52, v52, v225
    v_mul_f32 v53, v53, v225
    v_mul_f32 v54, v54, v225
    v_mul_f32 v55, v55, v225
    v_mul_f32 v56, v56, v225
    v_mul_f32 v57, v57, v225
    v_mul_f32 v58, v58, v225
    v_mul_f32 v59, v59, v225
    v_mul_f32 v60, v60, v225
    v_mul_f32 v61, v61, v225
    v_mul_f32 v62, v62, v225
    v_mul_f32 v63, v63, v225
    v_mul_f32 v104, v104, v224
    v_mul_f32 v105, v105, v224
    v_mul_f32 v106, v106, v224
    v_mul_f32 v107, v107, v224
    v_mul_f32 v108, v108, v225
    v_mul_f32 v109, v109, v225
    v_mul_f32 v110, v110, v225
    v_mul_f32 v111, v111, v225
    v_lshlrev_b32 v192, 16, v144
    v_and_b32 v193, 0xffff0000, v144
    v_mul_f32 v192, v192, v224
    v_mul_f32 v193, v193, v224
    v_cvt_pk_bf16_f32 v144, v192, v193
    v_lshlrev_b32 v192, 16, v145
    v_and_b32 v193, 0xffff0000, v145
    v_mul_f32 v192, v192, v224
    v_mul_f32 v193, v193, v224
    v_cvt_pk_bf16_f32 v145, v192, v193
    v_lshlrev_b32 v192, 16, v146
    v_and_b32 v193, 0xffff0000, v146
    v_mul_f32 v192, v192, v224
    v_mul_f32 v193, v193, v224
    v_cvt_pk_bf16_f32 v146, v192, v193
    v_lshlrev_b32 v192, 16, v147
    v_and_b32 v193, 0xffff0000, v147
    v_mul_f32 v192, v192, v224
    v_mul_f32 v193, v193, v224
    v_cvt_pk_bf16_f32 v147, v192, v193
    v_lshlrev_b32 v192, 16, v148
    v_and_b32 v193, 0xffff0000, v148
    v_mul_f32 v192, v192, v225
    v_mul_f32 v193, v193, v225
    v_cvt_pk_bf16_f32 v148, v192, v193
    v_lshlrev_b32 v192, 16, v149
    v_and_b32 v193, 0xffff0000, v149
    v_mul_f32 v192, v192, v225
    v_mul_f32 v193, v193, v225
    v_cvt_pk_bf16_f32 v149, v192, v193
    v_lshlrev_b32 v192, 16, v150
    v_and_b32 v193, 0xffff0000, v150
    v_mul_f32 v192, v192, v225
    v_mul_f32 v193, v193, v225
    v_cvt_pk_bf16_f32 v150, v192, v193
    v_lshlrev_b32 v192, 16, v151
    v_and_b32 v193, 0xffff0000, v151
    v_mul_f32 v192, v192, v225
    v_mul_f32 v193, v193, v225
    v_cvt_pk_bf16_f32 v151, v192, v193
    v_exp_f32 v192, v128
    v_exp_f32 v193, v129
    v_exp_f32 v194, v130
    v_cvt_pk_bf16_f32 v152, v192, v193
    v_exp_f32 v195, v131
    v_exp_f32 v196, v132
    v_cvt_pk_bf16_f32 v153, v194, v195
    v_exp_f32 v197, v133
    v_exp_f32 v198, v134
    v_cvt_pk_bf16_f32 v154, v196, v197
    v_exp_f32 v199, v135
    v_exp_f32 v192, v136
    v_cvt_pk_bf16_f32 v155, v198, v199
    v_exp_f32 v193, v137
    v_exp_f32 v194, v138
    v_cvt_pk_bf16_f32 v156, v192, v193
    v_exp_f32 v195, v139
    v_exp_f32 v196, v140
    v_cvt_pk_bf16_f32 v157, v194, v195
    v_exp_f32 v197, v141
    v_exp_f32 v198, v142
    v_cvt_pk_bf16_f32 v158, v196, v197
    v_exp_f32 v199, v143
    s_nop 0
    v_cvt_pk_bf16_f32 v159, v198, v199
    v_exp_f32 v192, v112
    s_nop 1
    s_setpc_b64 s[6:7]
L_code_end:
.section .rodata,"a"
.p2align 6
.amdhsa_kernel standalone__gqa_block_cached__near_ridge_kernel
  .amdhsa_next_free_vgpr 256
  .amdhsa_next_free_sgpr 96
  .amdhsa_accum_offset 256
  .amdhsa_group_segment_fixed_size 0
  .amdhsa_kernarg_size 64
  .amdhsa_user_sgpr_count 2
  .amdhsa_user_sgpr_kernarg_segment_ptr 1
  .amdhsa_system_sgpr_workgroup_id_x 1
.end_amdhsa_kernel
```
